```python
import torch

def _softmax(x, axis=-1):
    return torch.softmax(x, dim=axis)

def _gelu(x):
    return torch.nn.functional.gelu(x, approximate='tanh')

def _silu(x):
    return torch.nn.functional.silu(x)

def _sigmoid(x):
    return torch.sigmoid(x)

def _layernorm(x, axis=-1, eps=1e-05):
    m = x.mean(dim=axis, keepdim=True)
    v = x.var(dim=axis, keepdim=True, unbiased=False)
    return (x - m) / torch.sqrt(v + eps)

def _scatter_add(tgt, idx, src, axis=0):
    return tgt.clone().index_add_(axis, idx, src)

def _segment_sum(src, seg, n):
    out = torch.zeros((n,) + src.shape[1:], dtype=src.dtype)
    return out.index_add_(0, seg, src)

def _pad(x, pw):
    flat = tuple((v for pair in reversed(pw) for v in pair))
    return torch.nn.functional.pad(x, flat)
kernel_name = 'adaLN_cond__compressed_kv_cla__geglu_ffn__decode'

def setup_inputs():

    _w = lambda a: (lambda t: t.to(torch.bfloat16) if t.is_floating_point() else t)(torch.as_tensor(a))

    def _A_setup():
        B, H, Sq, Sk, D, M = (1, 32, 1, 16384, 128, 576)
        Dc = 4 * D
        return {'x': _w((lambda *s: torch.randn(*s, dtype=torch.bfloat16) * 0.05)(B, Sq, M)), 'c_kv': _w((lambda *s: torch.randn(*s, dtype=torch.bfloat16) * 1.6)(B, Sk, Dc)), 'w_q': _w((lambda *s: torch.randn(*s, dtype=torch.bfloat16) * 0.8)(M, H, D) * M ** (-0.5)), 'w_uk': _w((lambda *s: torch.randn(*s, dtype=torch.bfloat16) * 0.8)(Dc, H, D) * Dc ** (-0.5)), 'w_uv': _w((lambda *s: torch.randn(*s, dtype=torch.bfloat16) * 1.6)(Dc, H, D) * Dc ** (-0.5)), 'w_o': _w((lambda *s: torch.randn(*s, dtype=torch.bfloat16) * 1.6)(H, D, M) * (H * D) ** (-0.5))}
    _A_in = _A_setup()

    def _B_setup():
        B, S, D, F = (1, 1, 576, 4608)
        return {'x': _w((lambda *s: torch.randn(*s, dtype=torch.bfloat16) * 0.05)(B, S, D)), 'w_gate': _w((lambda *s: torch.randn(*s, dtype=torch.bfloat16) * 0.05)(D, F)), 'w_up': _w((lambda *s: torch.randn(*s, dtype=torch.bfloat16) * 0.05)(D, F)), 'w_down': _w((lambda *s: torch.randn(*s, dtype=torch.bfloat16) * 0.05)(F, D))}
    _B_in = _B_setup()
    return {'A_x': _A_in['x'], 'A_c_kv': _A_in['c_kv'], 'A_w_q': _A_in['w_q'], 'A_w_uk': _A_in['w_uk'], 'A_w_uv': _A_in['w_uv'], 'A_w_o': _A_in['w_o'], 'B_x': _B_in['x'], 'B_w_gate': _B_in['w_gate'], 'B_w_up': _B_in['w_up'], 'B_w_down': _B_in['w_down'], 'c': _w((lambda *s: torch.randn(*s, dtype=torch.bfloat16) * 0.1)(1, 576) * 8.0), 'w_mod': _w((lambda *s: torch.randn(*s, dtype=torch.bfloat16) * 0.1)(576, 6 * 576) * 576 ** (-0.5) * 8.0)}

def reference(A_x, A_c_kv, A_w_q, A_w_uk, A_w_uv, A_w_o, B_x, B_w_gate, B_w_up, B_w_down, c, w_mod):

    def _A_ref(x, c_kv, w_q, w_uk, w_uv, w_o):
        B, Sq, M = (x.shape[0], x.shape[1], x.shape[2])
        Sk = c_kv.shape[1]
        H, D = (w_q.shape[1], w_q.shape[2])
        q = torch.einsum('bqm,mhd->bhqd', x, w_q)
        k = torch.einsum('bkc,chd->bhkd', c_kv, w_uk)
        v = torch.einsum('bkc,chd->bhkd', c_kv, w_uv)
        scores = torch.einsum('bhqd,bhkd->bhqk', q, k) * D ** (-0.5)
        off = Sk - Sq
        qi = torch.arange(Sq)[:, None]
        kj = torch.arange(Sk)[None, :]
        cmask = kj <= qi + off
        scores = torch.where(cmask[None, None], scores, -1000000000.0)
        p = _softmax(scores, axis=-1)
        ctx = torch.einsum('bhqk,bhkd->bhqd', p, v)
        return torch.einsum('bhqd,hdm->bqm', ctx, w_o)

    def _B_ref(x, w_gate, w_up, w_down):
        return _gelu(x @ w_gate) * (x @ w_up) @ w_down
    x = A_x
    mod = (_silu(c) @ w_mod).reshape(c.shape[0], 6, 1, -1)
    sa, ca, ga, sb, cb, gb = (mod[:, 0].clone(), mod[:, 1].clone(), mod[:, 2].clone(), mod[:, 3].clone(), mod[:, 4].clone(), mod[:, 5].clone())
    h = _layernorm(x, axis=-1) * (1 + ca) + sa
    x = x + ga * _A_ref(h, A_c_kv, A_w_q, A_w_uk, A_w_uv, A_w_o)
    h = _layernorm(x, axis=-1) * (1 + cb) + sb
    x = x + gb * _B_ref(h, B_w_gate, B_w_up, B_w_down)
    return x
```

```asm
; @launch grid=(256,1,1) block=(512,1,1) lds=163840
.amdgcn_target "amdgcn-amd-amdhsa--gfx950"
.text
.globl adaLN_cond__compressed_kv_cla__geglu_ffn__decode_kernel
.p2align 10
.type adaLN_cond__compressed_kv_cla__geglu_ffn__decode_kernel,@function
adaLN_cond__compressed_kv_cla__geglu_ffn__decode_kernel:
    s_cmp_ge_u32 s2, 256
    s_cbranch_scc1 L_END
    s_load_dwordx16 s[16:31], s[0:1], 0
    s_load_dwordx8 s[32:39], s[0:1], 64
    s_load_dwordx2 s[40:41], s[0:1], 96
    s_load_dwordx2 s[42:43], s[0:1], 112
    v_and_b32 v1, 63, v0
    v_lshrrev_b32 v10, 6, v0
    v_and_b32 v2, 15, v0
    v_readfirstlane_b32 s5, v10
    v_lshrrev_b32 v3, 4, v1
    s_and_b32 s3, s2, 7
    s_lshr_b32 s4, s2, 3
    s_cmp_ge_u32 s4, 16
    s_cbranch_scc1 L_WY
    s_cmp_eq_u32 s5, 0
    s_cbranch_scc1 PAD_29
    s_cmp_eq_u32 s5, 1
    s_cbranch_scc1 PAD_3
    s_cmp_eq_u32 s5, 2
    s_cbranch_scc1 PAD_31
    s_cmp_eq_u32 s5, 3
    s_cbranch_scc1 PAD_7
    s_cmp_eq_u32 s5, 4
    s_cbranch_scc1 L_WRET
    s_cmp_eq_u32 s5, 5
    s_cbranch_scc1 PAD_0
    s_cmp_eq_u32 s5, 6
    s_cbranch_scc1 PAD_30
    s_branch PAD_1
L_WY:
    s_cmp_eq_u32 s5, 0
    s_cbranch_scc1 PAD_11
    s_cmp_eq_u32 s5, 1
    s_cbranch_scc1 PAD_17
    s_cmp_eq_u32 s5, 2
    s_cbranch_scc1 PAD_18
    s_cmp_eq_u32 s5, 3
    s_cbranch_scc1 PAD_20
    s_cmp_eq_u32 s5, 4
    s_cbranch_scc1 PAD_23
    s_cmp_eq_u32 s5, 5
    s_cbranch_scc1 PAD_33
    s_cmp_eq_u32 s5, 6
    s_cbranch_scc1 PAD_14
    s_branch PAD_16
L_WRET:
    s_mov_b32 s98, 0
    v_and_b32 v10, 1, v2
    v_cmp_eq_u32 vcc, 1, v10
    v_mov_b32 v11, 0xffff
    v_mov_b32 v12, 0xffff0000
    v_cndmask_b32 v13, v11, v12, vcc
    v_bfe_u32 v10, v2, 1, 2
    v_cmp_eq_u32 vcc, 0, v10
    s_nop 1
    v_cndmask_b32 v4, 0, v13, vcc
    v_cmp_eq_u32 vcc, 1, v10
    s_nop 1
    v_cndmask_b32 v5, 0, v13, vcc
    v_cmp_eq_u32 vcc, 2, v10
    s_nop 1
    v_cndmask_b32 v6, 0, v13, vcc
    v_cmp_eq_u32 vcc, 3, v10
    s_nop 1
    v_cndmask_b32 v7, 0, v13, vcc
    v_bfe_u32 v10, v2, 2, 1
    v_cmp_eq_u32 vcc, 1, v10
    s_nop 1
    v_cndmask_b32 v13, v11, v12, vcc
    v_cmp_gt_u32 vcc, 8, v2
    s_nop 1
    v_cndmask_b32 v18, 0, v13, vcc
    v_cndmask_b32 v19, v13, 0, vcc
    v_and_b32 v8, 0x3f803f80, v18
    v_and_b32 v9, 0x3f803f80, v19
    s_waitcnt lgkmcnt(0)
    s_load_dword s99, s[42:43], 0
    s_mov_b32 s44, s42
    s_mov_b32 s45, s43
    s_mov_b32 s46, 0x800000
    s_mov_b32 s47, 0x00020000
    s_sub_u32 s8, s4, 16
    s_cbranch_scc0 L_Y
L_X:
    s_cmp_lt_u32 s5, 4
    s_cbranch_scc1 L_XS
    s_mov_b32 s91, 0
    s_cmp_lg_u32 s5, 4
    s_cbranch_scc1 L_XM1
    s_cmp_ge_u32 s4, 11
    s_cbranch_scc1 L_XM1
    s_mov_b32 s91, 1
    s_add_u32 s14, s4, 16
    s_cmp_lt_u32 s4, 9
    s_cselect_b32 s14, s4, s14
    s_mov_b32 s15, s3
    s_mov_b32 s48, s38
    s_mov_b32 s49, s39
    s_mov_b32 s50, 0x3cc000
    s_mov_b32 s51, 0x00020000
    s_mov_b32 s60, s36
    s_mov_b32 s61, s37
    s_mov_b32 s62, 0x480
    s_mov_b32 s63, 0x00020000
    v_lshl_add_u32 v21, v2, 2, v3
    v_lshlrev_b32 v21, 1, v21
    v_lshrrev_b32 v22, 3, v2
    v_lshl_add_u32 v22, v22, 2, v3
    v_lshlrev_b32 v22, 1, v22
    s_mul_i32 s8, s15, 144
    v_mul_u32_u24 v23, 6912, v3
    v_lshl_add_u32 v23, v2, 4, v23
    s_mul_i32 s9, s15, 497664
    s_lshl_b32 s10, s14, 8
    s_add_u32 s9, s9, s10
    v_add_u32 v20, 221184, v23
    s_add_u32 s10, s9, 221184
    s_movk_i32 s11, 27648
    buffer_load_ushort v24, v21, s[60:63], s8 offen
    buffer_load_ushort v25, v22, s[60:63], s8 offen offset:128
    buffer_load_dwordx4 v[32:35], v20, s[48:51], s10 offen nt
    s_add_u32 s10, s10, s11
    buffer_load_dwordx4 v[36:39], v20, s[48:51], s10 offen nt
    buffer_load_dwordx4 v[40:43], v23, s[48:51], s9 offen nt
    buffer_load_dwordx4 v[44:47], v20, s[48:51], s9 offen nt
    s_add_u32 s9, s9, s11
    buffer_load_dwordx4 v[48:51], v23, s[48:51], s9 offen nt
    buffer_load_dwordx4 v[52:55], v20, s[48:51], s9 offen nt
    s_add_u32 s9, s9, s11
    buffer_load_dwordx4 v[56:59], v23, s[48:51], s9 offen nt
    buffer_load_dwordx4 v[60:63], v20, s[48:51], s9 offen nt
    s_add_u32 s9, s9, s11
    buffer_load_dwordx4 v[64:67], v23, s[48:51], s9 offen nt
    buffer_load_dwordx4 v[68:71], v20, s[48:51], s9 offen nt
    s_add_u32 s9, s9, s11
    buffer_load_dwordx4 v[72:75], v23, s[48:51], s9 offen nt
    buffer_load_dwordx4 v[76:79], v20, s[48:51], s9 offen nt
    s_add_u32 s9, s9, s11
    buffer_load_dwordx4 v[80:83], v23, s[48:51], s9 offen nt
    buffer_load_dwordx4 v[84:87], v20, s[48:51], s9 offen nt
    s_add_u32 s9, s9, s11
    buffer_load_dwordx4 v[88:91], v23, s[48:51], s9 offen nt
    buffer_load_dwordx4 v[92:95], v20, s[48:51], s9 offen nt
    s_add_u32 s9, s9, s11
    buffer_load_dwordx4 v[96:99], v23, s[48:51], s9 offen nt
    buffer_load_dwordx4 v[100:103], v20, s[48:51], s9 offen nt
L_XM1:
    s_sub_u32 s90, s5, 4
    s_lshl_b32 s8, s90, 13
    v_lshrrev_b32 v242, 5, v1
    v_lshlrev_b32 v242, 4, v242
    v_lshlrev_b32 v240, 3, v1
    v_xor_b32 v240, v240, v242
    v_add_u32 v240, s8, v240
    v_mov_b32 v243, s8
    v_mov_b32 v242, 0
    ds_write_b32 v243, v242 offset:6144
    ds_write_b32 v243, v242 offset:6148
    v_lshlrev_b32 v241, 4, v1
    s_waitcnt lgkmcnt(0)
    s_or_b32 s6, s99, 0x40004000
    s_add_u32 s6, s6, 1
    s_and_b32 s6, s6, 0xbfffbfff
    s_cmp_lg_u32 s5, 5
    s_cbranch_scc1 L_XD5
    s_getreg_b32 s9, hwreg(HW_REG_XCC_ID, 0, 4)
    s_lshl_b32 s8, s3, 8
    s_and_b32 s10, s2, 0xf8
    s_add_u32 s8, s8, s10
    s_add_u32 s8, s8, 4096
    v_mov_b32 v244, s9
    v_mov_b32 v245, s6
    v_mov_b32 v246, 0
    s_mov_b32 exec_lo, 0x1
    s_mov_b32 exec_hi, 0x0
    buffer_store_dwordx2 v[244:245], v246, s[44:47], s8 offen
    s_mov_b64 exec, -1
L_XD5:
    s_barrier
    s_cmp_eq_u32 s91, 0
    s_cbranch_scc1 L_XM2
    s_mul_i32 s9, s15, 13824
    s_lshl_b32 s10, s14, 9
    s_add_u32 s9, s9, s10
    s_add_u32 s9, s9, 65536
    v_lshlrev_b32 v21, 5, v2
    v_lshl_add_u32 v21, v3, 4, v21
    v_mov_b32 v30, s6
    v_mov_b32 v31, s6
    s_waitcnt vmcnt(18)
    v_lshlrev_b32 v24, 16, v24
    v_mul_f32 v26, 0xbfb8aa3b, v24
    v_exp_f32 v26, v26
    s_nop 0
    v_add_f32 v26, 1.0, v26
    v_rcp_f32 v26, v26
    s_nop 0
    v_mul_f32 v24, v24, v26
    v_cvt_pk_bf16_f32 v24, v24, v24
    v_lshlrev_b32 v25, 16, v25
    v_mul_f32 v27, 0xbfb8aa3b, v25
    v_exp_f32 v27, v27
    s_nop 0
    v_add_f32 v27, 1.0, v27
    v_rcp_f32 v27, v27
    s_nop 0
    v_mul_f32 v25, v25, v27
    v_cvt_pk_bf16_f32 v25, v25, v25
    v_mov_b32 v26, v24
    v_mov_b32 v27, v24
    s_nop 0
    v_mov_b32_dpp v26, v24 row_shr:4 row_mask:0xf bank_mask:0xa
    v_mov_b32_dpp v27, v24 row_shl:4 row_mask:0xf bank_mask:0x5
    v_and_b32 v10, v25, v4
    v_and_b32 v11, v25, v5
    v_and_b32 v12, v25, v6
    v_and_b32 v13, v25, v7
    v_and_b32_dpp v14, v26, v4 quad_perm:[0,0,0,0] row_mask:0xf bank_mask:0xf
    v_and_b32_dpp v15, v26, v5 quad_perm:[0,0,0,0] row_mask:0xf bank_mask:0xf
    v_and_b32_dpp v16, v26, v6 quad_perm:[0,0,0,0] row_mask:0xf bank_mask:0xf
    v_and_b32_dpp v17, v26, v7 quad_perm:[0,0,0,0] row_mask:0xf bank_mask:0xf
    s_branch PSK_29
PAD_29:
    s_branch L_WRET
PSK_29:
    s_waitcnt vmcnt(16)
    v_mfma_f32_16x16x32_bf16 v[160:163], v[10:13], v[32:35], 0
    v_mfma_f32_16x16x32_bf16 v[164:167], v[10:13], v[36:39], 0
    v_and_b32_dpp v10, v26, v4 quad_perm:[1,1,1,1] row_mask:0xf bank_mask:0xf
    v_and_b32_dpp v11, v26, v5 quad_perm:[1,1,1,1] row_mask:0xf bank_mask:0xf
    v_and_b32_dpp v12, v26, v6 quad_perm:[1,1,1,1] row_mask:0xf bank_mask:0xf
    v_and_b32_dpp v13, v26, v7 quad_perm:[1,1,1,1] row_mask:0xf bank_mask:0xf
    s_waitcnt vmcnt(14)
    v_mfma_f32_16x16x32_bf16 v[160:163], v[14:17], v[40:43], v[160:163]
    v_mfma_f32_16x16x32_bf16 v[164:167], v[14:17], v[44:47], v[164:167]
    v_and_b32_dpp v14, v26, v4 quad_perm:[2,2,2,2] row_mask:0xf bank_mask:0xf
    v_and_b32_dpp v15, v26, v5 quad_perm:[2,2,2,2] row_mask:0xf bank_mask:0xf
    v_and_b32_dpp v16, v26, v6 quad_perm:[2,2,2,2] row_mask:0xf bank_mask:0xf
    v_and_b32_dpp v17, v26, v7 quad_perm:[2,2,2,2] row_mask:0xf bank_mask:0xf
    s_waitcnt vmcnt(12)
    v_mfma_f32_16x16x32_bf16 v[160:163], v[10:13], v[48:51], v[160:163]
    v_mfma_f32_16x16x32_bf16 v[164:167], v[10:13], v[52:55], v[164:167]
    v_and_b32_dpp v10, v26, v4 quad_perm:[3,3,3,3] row_mask:0xf bank_mask:0xf
    v_and_b32_dpp v11, v26, v5 quad_perm:[3,3,3,3] row_mask:0xf bank_mask:0xf
    v_and_b32_dpp v12, v26, v6 quad_perm:[3,3,3,3] row_mask:0xf bank_mask:0xf
    v_and_b32_dpp v13, v26, v7 quad_perm:[3,3,3,3] row_mask:0xf bank_mask:0xf
    s_waitcnt vmcnt(10)
    v_mfma_f32_16x16x32_bf16 v[160:163], v[14:17], v[56:59], v[160:163]
    v_mfma_f32_16x16x32_bf16 v[164:167], v[14:17], v[60:63], v[164:167]
    v_and_b32_dpp v14, v27, v4 quad_perm:[0,0,0,0] row_mask:0xf bank_mask:0xf
    v_and_b32_dpp v15, v27, v5 quad_perm:[0,0,0,0] row_mask:0xf bank_mask:0xf
    v_and_b32_dpp v16, v27, v6 quad_perm:[0,0,0,0] row_mask:0xf bank_mask:0xf
    v_and_b32_dpp v17, v27, v7 quad_perm:[0,0,0,0] row_mask:0xf bank_mask:0xf
    s_waitcnt vmcnt(8)
    v_mfma_f32_16x16x32_bf16 v[160:163], v[10:13], v[64:67], v[160:163]
    v_mfma_f32_16x16x32_bf16 v[164:167], v[10:13], v[68:71], v[164:167]
    v_and_b32_dpp v10, v27, v4 quad_perm:[1,1,1,1] row_mask:0xf bank_mask:0xf
    v_and_b32_dpp v11, v27, v5 quad_perm:[1,1,1,1] row_mask:0xf bank_mask:0xf
    v_and_b32_dpp v12, v27, v6 quad_perm:[1,1,1,1] row_mask:0xf bank_mask:0xf
    v_and_b32_dpp v13, v27, v7 quad_perm:[1,1,1,1] row_mask:0xf bank_mask:0xf
    s_waitcnt vmcnt(6)
    v_mfma_f32_16x16x32_bf16 v[160:163], v[14:17], v[72:75], v[160:163]
    v_mfma_f32_16x16x32_bf16 v[164:167], v[14:17], v[76:79], v[164:167]
    v_and_b32_dpp v14, v27, v4 quad_perm:[2,2,2,2] row_mask:0xf bank_mask:0xf
    v_and_b32_dpp v15, v27, v5 quad_perm:[2,2,2,2] row_mask:0xf bank_mask:0xf
    v_and_b32_dpp v16, v27, v6 quad_perm:[2,2,2,2] row_mask:0xf bank_mask:0xf
    v_and_b32_dpp v17, v27, v7 quad_perm:[2,2,2,2] row_mask:0xf bank_mask:0xf
    s_waitcnt vmcnt(4)
    v_mfma_f32_16x16x32_bf16 v[160:163], v[10:13], v[80:83], v[160:163]
    v_mfma_f32_16x16x32_bf16 v[164:167], v[10:13], v[84:87], v[164:167]
    v_and_b32_dpp v10, v27, v4 quad_perm:[3,3,3,3] row_mask:0xf bank_mask:0xf
    v_and_b32_dpp v11, v27, v5 quad_perm:[3,3,3,3] row_mask:0xf bank_mask:0xf
    v_and_b32_dpp v12, v27, v6 quad_perm:[3,3,3,3] row_mask:0xf bank_mask:0xf
    v_and_b32_dpp v13, v27, v7 quad_perm:[3,3,3,3] row_mask:0xf bank_mask:0xf
    s_waitcnt vmcnt(2)
    v_mfma_f32_16x16x32_bf16 v[160:163], v[14:17], v[88:91], v[160:163]
    v_mfma_f32_16x16x32_bf16 v[164:167], v[14:17], v[92:95], v[164:167]
    s_waitcnt vmcnt(0)
    v_mfma_f32_16x16x32_bf16 v[160:163], v[10:13], v[96:99], v[160:163]
    v_mfma_f32_16x16x32_bf16 v[164:167], v[10:13], v[100:103], v[164:167]
    s_nop 7
    v_permlane32_swap_b32 v164, v162
    v_permlane32_swap_b32 v165, v163
    s_nop 0
    v_add_f32_dpp v22, v160, v162 quad_perm:[0,1,2,3] row_mask:0x3 bank_mask:0xf
    v_add_f32_dpp v23, v161, v163 quad_perm:[0,1,2,3] row_mask:0x3 bank_mask:0xf
    s_nop 0
    v_add_f32_dpp v22, v164, v166 quad_perm:[0,1,2,3] row_mask:0xc bank_mask:0xf
    v_add_f32_dpp v23, v165, v167 quad_perm:[0,1,2,3] row_mask:0xc bank_mask:0xf
    v_cvt_pk_bf16_f32 v28, v22, v23
    v_mov_b32 v29, v28
    s_nop 1
    v_permlane32_swap_b32 v28, v29
    s_mov_b32 exec_lo, 0xffffffff
    s_mov_b32 exec_hi, 0x0
    buffer_store_dwordx4 v[28:31], v21, s[44:47], s9 offen sc1
    s_mov_b64 exec, -1
L_XM2:
    v_bfe_u32 v26, v1, 2, 2
    v_lshrrev_b32 v27, 5, v1
    v_lshl_add_u32 v28, v27, 2, v26
    v_lshlrev_b32 v28, 8, v28
    v_lshl_or_b32 v26, v26, 2, v27
    v_bfe_u32 v27, v1, 4, 1
    v_bfe_u32 v29, v1, 1, 1
    v_lshl_or_b32 v27, v27, 1, v29
    v_xor_b32 v26, v26, v27
    s_lshl_b32 s8, s90, 2
    v_xor_b32 v26, s8, v26
    v_lshl_add_u32 v28, v26, 4, v28
    v_and_b32 v27, 1, v1
    v_lshl_add_u32 v28, v27, 3, v28
    v_add_u32 v10, 32768, v28
    v_xor_b32 v11, 32, v10
    v_add_u32 v11, 2048, v11
    v_add_u32 v12, 0x10000, v10
    v_add_u32 v13, 0x10000, v11
    s_and_b32 s89, s4, 3
    s_xor_b32 s8, s89, s90
    s_lshl_b32 s66, s8, 14
    s_add_u32 s66, s66, 262144
    s_add_u32 s67, s66, 4096
    s_add_u32 s68, s67, 4096
    s_add_u32 s69, s68, 4096
    v_lshrrev_b32 v27, 5, v1
    v_mul_u32_u24 v20, 130560, v27
    v_add_u32 v20, v20, v241
    s_lshl_b32 s8, s3, 4
    s_add_u32 s8, s8, s90
    s_lshl_b32 s70, s8, 15
    s_lshl_b32 s8, s4, 9
    s_add_u32 s70, s70, s8
    s_lshl_b32 s8, s89, 13
    s_add_u32 s70, s70, s8
    s_add_u32 s70, s70, 2097152
    s_add_u32 s71, s70, 262144
    s_lshl_b32 s8, s3, 2
    s_add_u32 s8, s8, s90
    s_lshl_b32 s72, s8, 8
    s_lshl_b32 s8, s4, 2
    s_add_u32 s72, s72, s8
    s_add_u32 s72, s72, 12288
    s_lshr_b32 s8, s89, 1
    s_lshl_b32 s8, s8, 7
    s_add_u32 s72, s72, s8
    s_xor_b32 s74, s72, 128
    s_mov_b32 s92, 0x42700000
    v_mov_b32 v21, s6
    v_mov_b32 v22, 0
    v_and_b32 v23, 31, v1
    v_lshlrev_b32 v23, 3, v23
    s_lshl_b32 s73, s3, 8
    s_add_u32 s73, s73, 4096
    s_barrier
    ds_read_b64_tr_b16 v[32:33], v10 offset:0
    ds_read_b64_tr_b16 v[34:35], v11 offset:0
    ds_read_b64_tr_b16 v[68:69], v10 offset:32768
    ds_read_b64_tr_b16 v[70:71], v11 offset:32768
    ds_read_b64_tr_b16 v[104:105], v12 offset:0
    ds_read_b64_tr_b16 v[106:107], v13 offset:0
    ds_read_b64_tr_b16 v[140:141], v12 offset:32768
    ds_read_b64_tr_b16 v[142:143], v13 offset:32768
    ds_read_b64_tr_b16 v[48:49], v10 offset:4096
    ds_read_b64_tr_b16 v[50:51], v11 offset:4096
    ds_read_b64_tr_b16 v[84:85], v10 offset:36864
    ds_read_b64_tr_b16 v[86:87], v11 offset:36864
    ds_read_b64_tr_b16 v[120:121], v12 offset:4096
    ds_read_b64_tr_b16 v[122:123], v13 offset:4096
    ds_read_b64_tr_b16 v[156:157], v12 offset:36864
    s_waitcnt lgkmcnt(0)
    ds_read_b64_tr_b16 v[158:159], v13 offset:36864
    ds_read_b64_tr_b16 v[64:65], v10 offset:8192
    ds_read_b64_tr_b16 v[66:67], v11 offset:8192
    ds_read_b64_tr_b16 v[36:37], v10 offset:40960
    ds_read_b64_tr_b16 v[38:39], v11 offset:40960
    ds_read_b64_tr_b16 v[136:137], v12 offset:8192
    ds_read_b64_tr_b16 v[138:139], v13 offset:8192
    ds_read_b64_tr_b16 v[108:109], v12 offset:40960
    ds_read_b64_tr_b16 v[110:111], v13 offset:40960
    ds_read_b64_tr_b16 v[80:81], v10 offset:12288
    ds_read_b64_tr_b16 v[82:83], v11 offset:12288
    ds_read_b64_tr_b16 v[52:53], v10 offset:45056
    ds_read_b64_tr_b16 v[54:55], v11 offset:45056
    ds_read_b64_tr_b16 v[152:153], v12 offset:12288
    ds_read_b64_tr_b16 v[154:155], v13 offset:12288
    s_waitcnt lgkmcnt(14)
    ds_read_b64_tr_b16 v[124:125], v12 offset:45056
    s_waitcnt lgkmcnt(0)
    ds_read_b64_tr_b16 v[126:127], v13 offset:45056
    ds_read_b64_tr_b16 v[96:97], v10 offset:16384
    ds_read_b64_tr_b16 v[98:99], v11 offset:16384
    ds_read_b64_tr_b16 v[132:133], v10 offset:49152
    ds_read_b64_tr_b16 v[134:135], v11 offset:49152
    ds_read_b64_tr_b16 v[40:41], v12 offset:16384
    ds_read_b64_tr_b16 v[42:43], v13 offset:16384
    ds_read_b64_tr_b16 v[76:77], v12 offset:49152
    ds_read_b64_tr_b16 v[78:79], v13 offset:49152
    ds_read_b64_tr_b16 v[112:113], v10 offset:20480
    ds_read_b64_tr_b16 v[114:115], v11 offset:20480
    ds_read_b64_tr_b16 v[148:149], v10 offset:53248
    ds_read_b64_tr_b16 v[150:151], v11 offset:53248
    ds_read_b64_tr_b16 v[56:57], v12 offset:20480
    ds_read_b64_tr_b16 v[58:59], v13 offset:20480
    s_waitcnt lgkmcnt(14)
    ds_read_b64_tr_b16 v[92:93], v12 offset:53248
    s_waitcnt lgkmcnt(0)
    ds_read_b64_tr_b16 v[94:95], v13 offset:53248
    s_mov_b32 s7, 400000
L_XGO:
    ds_read_b32 v242, v243 offset:6144
    s_waitcnt lgkmcnt(0)
    v_cmp_eq_u32 vcc, 0, v242
    s_cbranch_vccz L_XGO2
    s_sub_u32 s7, s7, 1
    s_cbranch_scc0 L_XGO
    s_branch L_XGO2
PAD_0:
    s_branch PAD_32
L_XGO2:
    buffer_load_dwordx2 v[24:25], v23, s[44:47], s73 offen sc1
    buffer_load_dwordx3 v[160:162], v241, s[44:47], s66 offen sc1
    buffer_load_dwordx3 v[164:166], v241, s[44:47], s66 offen offset:1024 sc1
    buffer_load_dwordx3 v[168:170], v241, s[44:47], s66 offen offset:2048 sc1
    buffer_load_dwordx3 v[172:174], v241, s[44:47], s66 offen offset:3072 sc1
    buffer_load_dwordx3 v[176:178], v241, s[44:47], s67 offen sc1
    buffer_load_dwordx3 v[180:182], v241, s[44:47], s67 offen offset:1024 sc1
    buffer_load_dwordx3 v[184:186], v241, s[44:47], s67 offen offset:2048 sc1
    buffer_load_dwordx3 v[188:190], v241, s[44:47], s67 offen offset:3072 sc1
    buffer_load_dwordx3 v[192:194], v241, s[44:47], s68 offen sc1
    buffer_load_dwordx3 v[196:198], v241, s[44:47], s68 offen offset:1024 sc1
    buffer_load_dwordx3 v[200:202], v241, s[44:47], s68 offen offset:2048 sc1
    buffer_load_dwordx3 v[204:206], v241, s[44:47], s68 offen offset:3072 sc1
    buffer_load_dwordx3 v[208:210], v241, s[44:47], s69 offen sc1
    buffer_load_dwordx3 v[212:214], v241, s[44:47], s69 offen offset:1024 sc1
    buffer_load_dwordx3 v[216:218], v241, s[44:47], s69 offen offset:2048 sc1
    buffer_load_dwordx3 v[220:222], v241, s[44:47], s69 offen offset:3072 sc1
    s_barrier
    ds_read_b64_tr_b16 v[128:129], v10 offset:24576
    ds_read_b64_tr_b16 v[130:131], v11 offset:24576
    ds_read_b64_tr_b16 v[100:101], v10 offset:57344
    ds_read_b64_tr_b16 v[102:103], v11 offset:57344
    ds_read_b64_tr_b16 v[72:73], v12 offset:24576
    ds_read_b64_tr_b16 v[74:75], v13 offset:24576
    ds_read_b64_tr_b16 v[44:45], v12 offset:57344
    ds_read_b64_tr_b16 v[46:47], v13 offset:57344
    ds_read_b64_tr_b16 v[144:145], v10 offset:28672
    ds_read_b64_tr_b16 v[146:147], v11 offset:28672
    ds_read_b64_tr_b16 v[116:117], v10 offset:61440
    ds_read_b64_tr_b16 v[118:119], v11 offset:61440
    ds_read_b64_tr_b16 v[88:89], v12 offset:28672
    ds_read_b64_tr_b16 v[90:91], v13 offset:28672
    ds_read_b64_tr_b16 v[60:61], v12 offset:61440
    s_waitcnt lgkmcnt(0)
    ds_read_b64_tr_b16 v[62:63], v13 offset:61440
    s_waitcnt vmcnt(12)
    v_bitop3_b32 v31, v162, v166, s6 bitop3:0x7e
    v_bitop3_b32 v31, v31, v170, s6 bitop3:0xf6
    v_bitop3_b32 v31, v31, v174, s6 bitop3:0xf6
    v_cmp_ne_u32 vcc, 0, v31
    s_cbranch_vccnz RC_1
RC_2:
    ds_write_b64 v240, v[160:161] offset:0
    ds_write_b64 v240, v[164:165] offset:512
    ds_write_b64 v240, v[168:169] offset:1024
    ds_write_b64 v240, v[172:173] offset:1536
    s_waitcnt lgkmcnt(0)
    s_barrier
    s_waitcnt vmcnt(8)
    v_bitop3_b32 v31, v178, v182, s6 bitop3:0x7e
    v_bitop3_b32 v31, v31, v186, s6 bitop3:0xf6
    v_bitop3_b32 v31, v31, v190, s6 bitop3:0xf6
    v_cmp_ne_u32 vcc, 0, v31
    s_cbranch_vccnz RC_3
RC_4:
    ds_write_b64 v240, v[176:177] offset:2048
    ds_write_b64 v240, v[180:181] offset:2560
    ds_write_b64 v240, v[184:185] offset:3072
    ds_write_b64 v240, v[188:189] offset:3584
    s_waitcnt lgkmcnt(0)
    s_barrier
    s_waitcnt vmcnt(4)
    v_bitop3_b32 v31, v194, v198, s6 bitop3:0x7e
    v_bitop3_b32 v31, v31, v202, s6 bitop3:0xf6
    v_bitop3_b32 v31, v31, v206, s6 bitop3:0xf6
    v_cmp_ne_u32 vcc, 0, v31
    s_cbranch_vccnz RC_5
RC_6:
    ds_write_b64 v240, v[192:193] offset:4096
    ds_write_b64 v240, v[196:197] offset:4608
    ds_write_b64 v240, v[200:201] offset:5120
    ds_write_b64 v240, v[204:205] offset:5632
    s_waitcnt lgkmcnt(0)
    s_barrier
    s_waitcnt vmcnt(0)
    v_bitop3_b32 v31, v210, v214, s6 bitop3:0x7e
    v_bitop3_b32 v31, v31, v218, s6 bitop3:0xf6
    v_bitop3_b32 v31, v31, v222, s6 bitop3:0xf6
    v_cmp_ne_u32 vcc, 0, v31
    s_cbranch_vccnz RC_7
RC_8:
    ds_write_b64 v240, v[208:209] offset:6144
    ds_write_b64 v240, v[212:213] offset:6656
    ds_write_b64 v240, v[216:217] offset:7168
    ds_write_b64 v240, v[220:221] offset:7680
    s_waitcnt lgkmcnt(0)
    s_barrier
    s_getreg_b32 s9, hwreg(HW_REG_XCC_ID, 0, 4)
    v_xor_b32 v24, s9, v24
    v_xor_b32 v25, s6, v25
    v_or_b32 v24, v24, v25
    v_cmp_ne_u32 vcc, 0, v24
    s_cmp_eq_u64 vcc, 0
    s_cselect_b32 s98, 1, 0
L_XP1:
    s_barrier
    ds_read_b128 v[24:27], v241 offset:40960
    ds_read_b128 v[192:195], v241 offset:32768
    ds_read_b128 v[196:199], v241 offset:33792
    ds_read_b128 v[200:203], v241 offset:34816
    ds_read_b128 v[204:207], v241 offset:35840
    ds_read_b128 v[208:211], v241 offset:36864
    ds_read_b128 v[212:215], v241 offset:37888
    ds_read_b128 v[216:219], v241 offset:38912
    ds_read_b128 v[220:223], v241 offset:39936
    s_waitcnt lgkmcnt(8)
    v_max3_f32 v31, |v24|, |v25|, |v26|
    v_max_f32_e64 v31, |v27|, v31
    v_cmp_lt_f32 vcc, s92, v31
    s_cbranch_vccnz L_XPSLOW
    s_cmp_eq_u32 s98, 0
    s_waitcnt lgkmcnt(7)
    v_mfma_f32_32x32x16_bf16 v[160:175], v[192:195], v[32:35], 0
    s_waitcnt lgkmcnt(6)
    v_mfma_f32_32x32x16_bf16 v[160:175], v[196:199], v[36:39], v[160:175]
    s_waitcnt lgkmcnt(5)
    v_mfma_f32_32x32x16_bf16 v[160:175], v[200:203], v[40:43], v[160:175]
    s_waitcnt lgkmcnt(4)
    v_mfma_f32_32x32x16_bf16 v[160:175], v[204:207], v[44:47], v[160:175]
    s_waitcnt lgkmcnt(3)
    v_mfma_f32_32x32x16_bf16 v[160:175], v[208:211], v[48:51], v[160:175]
    s_waitcnt lgkmcnt(2)
    v_mfma_f32_32x32x16_bf16 v[160:175], v[212:215], v[52:55], v[160:175]
    s_waitcnt lgkmcnt(1)
    v_mfma_f32_32x32x16_bf16 v[160:175], v[216:219], v[56:59], v[160:175]
    s_waitcnt lgkmcnt(0)
    v_mfma_f32_32x32x16_bf16 v[160:175], v[220:223], v[60:63], v[160:175]
    s_cbranch_scc1 L_XH2C
    v_mfma_f32_32x32x16_bf16 v[176:191], v[192:195], v[64:67], 0
    v_mfma_f32_32x32x16_bf16 v[176:191], v[196:199], v[68:71], v[176:191]
    s_nop 9
    v_cvt_pk_bf16_f32 v32, v160, v161
    v_cvt_pk_bf16_f32 v33, v162, v163
    v_cvt_pk_bf16_f32 v34, v164, v165
    v_cvt_pk_bf16_f32 v35, v166, v167
    buffer_store_dwordx4 v[32:35], v20, s[44:47], s70 offen nt
    s_xor_b32 s70, s70, 8192
    v_mfma_f32_32x32x16_bf16 v[176:191], v[200:203], v[72:75], v[176:191]
    v_cvt_pk_bf16_f32 v36, v168, v169
    v_cvt_pk_bf16_f32 v37, v170, v171
    v_cvt_pk_bf16_f32 v38, v172, v173
    v_cvt_pk_bf16_f32 v39, v174, v175
    buffer_store_dwordx4 v[36:39], v20, s[44:47], s71 offen nt
    s_xor_b32 s71, s71, 8192
    v_mfma_f32_32x32x16_bf16 v[176:191], v[204:207], v[76:79], v[176:191]
    v_mfma_f32_32x32x16_bf16 v[176:191], v[208:211], v[80:83], v[176:191]
    v_mfma_f32_32x32x16_bf16 v[176:191], v[212:215], v[84:87], v[176:191]
    s_branch PSK_30
PAD_30:
    s_branch PAD_8
PSK_30:
    s_barrier
    v_mfma_f32_32x32x16_bf16 v[176:191], v[216:219], v[88:91], v[176:191]
    v_mfma_f32_32x32x16_bf16 v[176:191], v[220:223], v[92:95], v[176:191]
    v_mfma_f32_32x32x16_bf16 v[160:175], v[192:195], v[96:99], 0
    v_mfma_f32_32x32x16_bf16 v[160:175], v[196:199], v[100:103], v[160:175]
    s_nop 9
    v_cvt_pk_bf16_f32 v64, v176, v177
    v_cvt_pk_bf16_f32 v65, v178, v179
    v_cvt_pk_bf16_f32 v66, v180, v181
    v_cvt_pk_bf16_f32 v67, v182, v183
    buffer_store_dwordx4 v[64:67], v20, s[44:47], s70 offen nt
    s_xor_b32 s70, s70, 24576
    v_mfma_f32_32x32x16_bf16 v[160:175], v[200:203], v[104:107], v[160:175]
    v_cvt_pk_bf16_f32 v68, v184, v185
    v_cvt_pk_bf16_f32 v69, v186, v187
    v_cvt_pk_bf16_f32 v70, v188, v189
    v_cvt_pk_bf16_f32 v71, v190, v191
    buffer_store_dwordx4 v[68:71], v20, s[44:47], s71 offen nt
    s_xor_b32 s71, s71, 24576
    v_mfma_f32_32x32x16_bf16 v[160:175], v[204:207], v[108:111], v[160:175]
    v_mfma_f32_32x32x16_bf16 v[160:175], v[208:211], v[112:115], v[160:175]
    v_mfma_f32_32x32x16_bf16 v[160:175], v[212:215], v[116:119], v[160:175]
    v_mfma_f32_32x32x16_bf16 v[160:175], v[216:219], v[120:123], v[160:175]
    v_mfma_f32_32x32x16_bf16 v[160:175], v[220:223], v[124:127], v[160:175]
    v_mfma_f32_32x32x16_bf16 v[176:191], v[192:195], v[128:131], 0
    v_mfma_f32_32x32x16_bf16 v[176:191], v[196:199], v[132:135], v[176:191]
    s_nop 9
    v_cvt_pk_bf16_f32 v96, v160, v161
    v_cvt_pk_bf16_f32 v97, v162, v163
    v_cvt_pk_bf16_f32 v98, v164, v165
    v_cvt_pk_bf16_f32 v99, v166, v167
    buffer_store_dwordx4 v[96:99], v20, s[44:47], s70 offen nt
    s_xor_b32 s70, s70, 8192
    v_mfma_f32_32x32x16_bf16 v[176:191], v[200:203], v[136:139], v[176:191]
    v_cvt_pk_bf16_f32 v100, v168, v169
    v_cvt_pk_bf16_f32 v101, v170, v171
    v_cvt_pk_bf16_f32 v102, v172, v173
    v_cvt_pk_bf16_f32 v103, v174, v175
    buffer_store_dwordx4 v[100:103], v20, s[44:47], s71 offen nt
    s_xor_b32 s71, s71, 8192
    v_mfma_f32_32x32x16_bf16 v[176:191], v[204:207], v[140:143], v[176:191]
    v_mfma_f32_32x32x16_bf16 v[176:191], v[208:211], v[144:147], v[176:191]
    v_mfma_f32_32x32x16_bf16 v[176:191], v[212:215], v[148:151], v[176:191]
    v_mfma_f32_32x32x16_bf16 v[176:191], v[216:219], v[152:155], v[176:191]
    s_mov_b32 exec_lo, 0x1
    s_mov_b32 exec_hi, 0x0
    s_waitcnt vmcnt(2)
    buffer_store_dword v21, v22, s[44:47], s72 offen
    s_mov_b64 exec, -1
    v_mfma_f32_32x32x16_bf16 v[176:191], v[220:223], v[156:159], v[176:191]
    s_nop 11
    v_cvt_pk_bf16_f32 v128, v176, v177
    v_cvt_pk_bf16_f32 v129, v178, v179
    v_cvt_pk_bf16_f32 v130, v180, v181
    v_cvt_pk_bf16_f32 v131, v182, v183
    buffer_store_dwordx4 v[128:131], v20, s[44:47], s70 offen nt
    s_xor_b32 s70, s70, 8192
    v_cvt_pk_bf16_f32 v132, v184, v185
    v_cvt_pk_bf16_f32 v133, v186, v187
    v_cvt_pk_bf16_f32 v134, v188, v189
    v_cvt_pk_bf16_f32 v135, v190, v191
    buffer_store_dwordx4 v[132:135], v20, s[44:47], s71 offen nt
    s_xor_b32 s71, s71, 8192
    s_mov_b32 exec_lo, 0x1
    s_mov_b32 exec_hi, 0x0
    s_waitcnt vmcnt(0)
    buffer_store_dword v21, v22, s[44:47], s74 offen
    s_mov_b64 exec, -1
L_XH2R:
    s_barrier
    s_barrier
L_XDN:
    s_mov_b32 s56, s34
    s_mov_b32 s57, s35
    s_mov_b32 s58, 0x510000
    s_mov_b32 s59, 0x00020000
    s_lshl_b32 s8, s90, 4
    s_add_u32 s8, s8, s4
    s_mul_i32 s9, s8, 57
    s_lshr_b32 s9, s9, 9
    s_mul_i32 s10, s9, 9
    s_sub_u32 s10, s8, s10
    s_lshl_b32 s8, s3, 3
    s_add_u32 s9, s9, s8
    s_mul_i32 s11, s9, 82944
    s_lshl_b32 s8, s10, 7
    s_add_u32 s11, s11, s8
    s_add_u32 s12, s11, 73728
    s_mul_i32 s13, s9, 576
    s_add_u32 s13, s13, 786432
    s_lshl_b32 s14, s10, 14
    s_lshl_b32 s8, s9, 8
    s_add_u32 s14, s14, s8
    s_add_u32 s14, s14, 524288
    v_lshrrev_b32 v30, 3, v2
    v_mul_u32_u24 v30, 32, v30
    v_add_u32 v30, v30, v3
    v_mul_u32_u24 v28, 1152, v30
    v_and_b32 v30, 7, v2
    v_lshl_add_u32 v28, v30, 4, v28
    v_lshrrev_b32 v30, 3, v2
    v_mul_u32_u24 v30, 4, v30
    v_add_u32 v30, v30, v3
    v_mul_u32_u24 v29, 1152, v30
    v_and_b32 v30, 7, v2
    v_lshl_add_u32 v29, v30, 4, v29
    buffer_load_dwordx4 v[64:67], v29, s[56:59], s12 offen nt
    buffer_load_dwordx4 v[32:35], v28, s[56:59], s11 offen nt
    s_add_u32 s11, s11, 4608
    buffer_load_dwordx4 v[36:39], v28, s[56:59], s11 offen nt
    s_add_u32 s11, s11, 4608
    buffer_load_dwordx4 v[40:43], v28, s[56:59], s11 offen nt
    s_add_u32 s11, s11, 4608
    buffer_load_dwordx4 v[44:47], v28, s[56:59], s11 offen nt
    s_add_u32 s11, s11, 4608
    buffer_load_dwordx4 v[48:51], v28, s[56:59], s11 offen nt
    s_add_u32 s11, s11, 4608
    buffer_load_dwordx4 v[52:55], v28, s[56:59], s11 offen nt
    s_add_u32 s11, s11, 4608
    buffer_load_dwordx4 v[56:59], v28, s[56:59], s11 offen nt
    s_add_u32 s11, s11, 4608
    buffer_load_dwordx4 v[60:63], v28, s[56:59], s11 offen nt
    v_lshl_add_u32 v21, v2, 2, v3
    v_lshlrev_b32 v21, 3, v21
    v_lshrrev_b32 v22, 3, v2
    v_lshl_add_u32 v22, v22, 2, v3
    v_lshlrev_b32 v22, 3, v22
    v_and_b32 v30, 1, v3
    v_lshl_add_u32 v30, v2, 1, v30
    v_lshlrev_b32 v24, 4, v30
    v_mov_b32 v82, s6
    v_mov_b32 v83, s6
    s_mov_b32 s7, 20000
PL_9:
    buffer_load_dwordx2 v[72:73], v21, s[44:47], s13 offen sc1
    buffer_load_dwordx2 v[74:75], v22, s[44:47], s13 offen offset:512 sc1
    s_waitcnt vmcnt(0)
    v_bitop3_b32 v30, v73, v75, s6 bitop3:0x7e
    v_cmp_ne_u32 vcc, 0, v30
    s_cbranch_vccz PD_10
    s_sub_u32 s7, s7, 1
    s_cbranch_scc0 PL_9
    s_branch PD_10
PAD_1:
    s_branch PAD_10
PD_10:
    v_mov_b32 v76, v72
    v_mov_b32 v77, v72
    s_nop 0
    v_mov_b32_dpp v76, v72 row_shr:4 row_mask:0xf bank_mask:0xa
    v_mov_b32_dpp v77, v72 row_shl:4 row_mask:0xf bank_mask:0x5
    v_and_b32 v10, v74, v4
    v_and_b32 v11, v74, v5
    v_and_b32 v12, v74, v6
    v_and_b32 v13, v74, v7
    v_and_b32_dpp v14, v76, v4 quad_perm:[0,0,0,0] row_mask:0xf bank_mask:0xf
    v_and_b32_dpp v15, v76, v5 quad_perm:[0,0,0,0] row_mask:0xf bank_mask:0xf
    v_and_b32_dpp v16, v76, v6 quad_perm:[0,0,0,0] row_mask:0xf bank_mask:0xf
    v_and_b32_dpp v17, v76, v7 quad_perm:[0,0,0,0] row_mask:0xf bank_mask:0xf
    v_mfma_f32_16x16x32_bf16 v[84:87], v[10:13], v[64:67], 0
    v_and_b32_dpp v10, v76, v4 quad_perm:[1,1,1,1] row_mask:0xf bank_mask:0xf
    v_and_b32_dpp v11, v76, v5 quad_perm:[1,1,1,1] row_mask:0xf bank_mask:0xf
    v_and_b32_dpp v12, v76, v6 quad_perm:[1,1,1,1] row_mask:0xf bank_mask:0xf
    v_and_b32_dpp v13, v76, v7 quad_perm:[1,1,1,1] row_mask:0xf bank_mask:0xf
    v_mfma_f32_16x16x32_bf16 v[84:87], v[14:17], v[32:35], v[84:87]
    v_and_b32_dpp v14, v76, v4 quad_perm:[2,2,2,2] row_mask:0xf bank_mask:0xf
    v_and_b32_dpp v15, v76, v5 quad_perm:[2,2,2,2] row_mask:0xf bank_mask:0xf
    v_and_b32_dpp v16, v76, v6 quad_perm:[2,2,2,2] row_mask:0xf bank_mask:0xf
    v_and_b32_dpp v17, v76, v7 quad_perm:[2,2,2,2] row_mask:0xf bank_mask:0xf
    v_mfma_f32_16x16x32_bf16 v[84:87], v[10:13], v[36:39], v[84:87]
    v_and_b32_dpp v10, v76, v4 quad_perm:[3,3,3,3] row_mask:0xf bank_mask:0xf
    v_and_b32_dpp v11, v76, v5 quad_perm:[3,3,3,3] row_mask:0xf bank_mask:0xf
    v_and_b32_dpp v12, v76, v6 quad_perm:[3,3,3,3] row_mask:0xf bank_mask:0xf
    v_and_b32_dpp v13, v76, v7 quad_perm:[3,3,3,3] row_mask:0xf bank_mask:0xf
    v_mfma_f32_16x16x32_bf16 v[84:87], v[14:17], v[40:43], v[84:87]
    v_and_b32_dpp v14, v77, v4 quad_perm:[0,0,0,0] row_mask:0xf bank_mask:0xf
    v_and_b32_dpp v15, v77, v5 quad_perm:[0,0,0,0] row_mask:0xf bank_mask:0xf
    v_and_b32_dpp v16, v77, v6 quad_perm:[0,0,0,0] row_mask:0xf bank_mask:0xf
    v_and_b32_dpp v17, v77, v7 quad_perm:[0,0,0,0] row_mask:0xf bank_mask:0xf
    v_mfma_f32_16x16x32_bf16 v[84:87], v[10:13], v[44:47], v[84:87]
    v_and_b32_dpp v10, v77, v4 quad_perm:[1,1,1,1] row_mask:0xf bank_mask:0xf
    v_and_b32_dpp v11, v77, v5 quad_perm:[1,1,1,1] row_mask:0xf bank_mask:0xf
    v_and_b32_dpp v12, v77, v6 quad_perm:[1,1,1,1] row_mask:0xf bank_mask:0xf
    v_and_b32_dpp v13, v77, v7 quad_perm:[1,1,1,1] row_mask:0xf bank_mask:0xf
    v_mfma_f32_16x16x32_bf16 v[84:87], v[14:17], v[48:51], v[84:87]
    v_and_b32_dpp v14, v77, v4 quad_perm:[2,2,2,2] row_mask:0xf bank_mask:0xf
    v_and_b32_dpp v15, v77, v5 quad_perm:[2,2,2,2] row_mask:0xf bank_mask:0xf
    v_and_b32_dpp v16, v77, v6 quad_perm:[2,2,2,2] row_mask:0xf bank_mask:0xf
    v_and_b32_dpp v17, v77, v7 quad_perm:[2,2,2,2] row_mask:0xf bank_mask:0xf
    v_mfma_f32_16x16x32_bf16 v[84:87], v[10:13], v[52:55], v[84:87]
    v_and_b32_dpp v10, v77, v4 quad_perm:[3,3,3,3] row_mask:0xf bank_mask:0xf
    v_and_b32_dpp v11, v77, v5 quad_perm:[3,3,3,3] row_mask:0xf bank_mask:0xf
    v_and_b32_dpp v12, v77, v6 quad_perm:[3,3,3,3] row_mask:0xf bank_mask:0xf
    v_and_b32_dpp v13, v77, v7 quad_perm:[3,3,3,3] row_mask:0xf bank_mask:0xf
    v_mfma_f32_16x16x32_bf16 v[84:87], v[14:17], v[56:59], v[84:87]
    s_nop 0
    v_mfma_f32_16x16x32_bf16 v[84:87], v[10:13], v[60:63], v[84:87]
    s_nop 7
    v_permlane32_swap_b32 v84, v86
    v_permlane32_swap_b32 v85, v87
    s_nop 0
    v_add_f32_dpp v84, v86, v84 row_ror:8 row_mask:0xf bank_mask:0xf
    v_add_f32_dpp v85, v87, v85 row_ror:8 row_mask:0xf bank_mask:0xf
    v_cvt_pk_bf16_f32 v80, v84, v85
    v_mov_b32 v81, v80
    s_nop 1
    v_permlane32_swap_b32 v80, v81
    s_mov_b32 exec_lo, 0xff00ff
    s_mov_b32 exec_hi, 0x0
    buffer_store_dwordx4 v[80:83], v24, s[44:47], s14 offen sc1
    s_endpgm
RC_1:
    s_mov_b32 s7, 20000
    s_waitcnt vmcnt(0)
FL_11:
    v_bitop3_b32 v31, v162, v166, s6 bitop3:0x7e
    v_bitop3_b32 v31, v31, v170, s6 bitop3:0xf6
    v_bitop3_b32 v31, v31, v174, s6 bitop3:0xf6
    v_bitop3_b32 v31, v31, v178, s6 bitop3:0xf6
    v_bitop3_b32 v31, v31, v182, s6 bitop3:0xf6
    v_bitop3_b32 v31, v31, v186, s6 bitop3:0xf6
    v_bitop3_b32 v31, v31, v190, s6 bitop3:0xf6
    v_bitop3_b32 v31, v31, v194, s6 bitop3:0xf6
    v_bitop3_b32 v31, v31, v198, s6 bitop3:0xf6
    v_bitop3_b32 v31, v31, v202, s6 bitop3:0xf6
    v_bitop3_b32 v31, v31, v206, s6 bitop3:0xf6
    v_bitop3_b32 v31, v31, v210, s6 bitop3:0xf6
    v_bitop3_b32 v31, v31, v214, s6 bitop3:0xf6
    v_bitop3_b32 v31, v31, v218, s6 bitop3:0xf6
    v_bitop3_b32 v31, v31, v222, s6 bitop3:0xf6
    v_cmp_ne_u32 vcc, 0, v31
    s_mov_b64 exec, vcc
    buffer_load_dwordx3 v[160:162], v241, s[44:47], s66 offen sc1
    buffer_load_dwordx3 v[164:166], v241, s[44:47], s66 offen offset:1024 sc1
    buffer_load_dwordx3 v[168:170], v241, s[44:47], s66 offen offset:2048 sc1
    buffer_load_dwordx3 v[172:174], v241, s[44:47], s66 offen offset:3072 sc1
    buffer_load_dwordx3 v[176:178], v241, s[44:47], s67 offen sc1
    buffer_load_dwordx3 v[180:182], v241, s[44:47], s67 offen offset:1024 sc1
    buffer_load_dwordx3 v[184:186], v241, s[44:47], s67 offen offset:2048 sc1
    buffer_load_dwordx3 v[188:190], v241, s[44:47], s67 offen offset:3072 sc1
    buffer_load_dwordx3 v[192:194], v241, s[44:47], s68 offen sc1
    buffer_load_dwordx3 v[196:198], v241, s[44:47], s68 offen offset:1024 sc1
    buffer_load_dwordx3 v[200:202], v241, s[44:47], s68 offen offset:2048 sc1
    buffer_load_dwordx3 v[204:206], v241, s[44:47], s68 offen offset:3072 sc1
    buffer_load_dwordx3 v[208:210], v241, s[44:47], s69 offen sc1
    buffer_load_dwordx3 v[212:214], v241, s[44:47], s69 offen offset:1024 sc1
    buffer_load_dwordx3 v[216:218], v241, s[44:47], s69 offen offset:2048 sc1
    buffer_load_dwordx3 v[220:222], v241, s[44:47], s69 offen offset:3072 sc1
    s_mov_b64 exec, -1
    s_waitcnt vmcnt(12)
    v_bitop3_b32 v31, v162, v166, s6 bitop3:0x7e
    v_bitop3_b32 v31, v31, v170, s6 bitop3:0xf6
    v_bitop3_b32 v31, v31, v174, s6 bitop3:0xf6
    v_cmp_ne_u32 vcc, 0, v31
    s_cbranch_vccz RC_2
    s_waitcnt vmcnt(0)
    s_sub_u32 s7, s7, 1
    s_cbranch_scc0 FL_11
    s_branch RC_2
PAD_2:
    s_branch L_WRET
RC_3:
    s_mov_b32 s7, 20000
    s_waitcnt vmcnt(0)
FL_12:
    v_bitop3_b32 v31, v178, v182, s6 bitop3:0x7e
    v_bitop3_b32 v31, v31, v186, s6 bitop3:0xf6
    v_bitop3_b32 v31, v31, v190, s6 bitop3:0xf6
    v_bitop3_b32 v31, v31, v194, s6 bitop3:0xf6
    v_bitop3_b32 v31, v31, v198, s6 bitop3:0xf6
    v_bitop3_b32 v31, v31, v202, s6 bitop3:0xf6
    v_bitop3_b32 v31, v31, v206, s6 bitop3:0xf6
    v_bitop3_b32 v31, v31, v210, s6 bitop3:0xf6
    v_bitop3_b32 v31, v31, v214, s6 bitop3:0xf6
    v_bitop3_b32 v31, v31, v218, s6 bitop3:0xf6
    v_bitop3_b32 v31, v31, v222, s6 bitop3:0xf6
    v_cmp_ne_u32 vcc, 0, v31
    s_mov_b64 exec, vcc
    buffer_load_dwordx3 v[176:178], v241, s[44:47], s67 offen sc1
    buffer_load_dwordx3 v[180:182], v241, s[44:47], s67 offen offset:1024 sc1
    buffer_load_dwordx3 v[184:186], v241, s[44:47], s67 offen offset:2048 sc1
    buffer_load_dwordx3 v[188:190], v241, s[44:47], s67 offen offset:3072 sc1
    buffer_load_dwordx3 v[192:194], v241, s[44:47], s68 offen sc1
    buffer_load_dwordx3 v[196:198], v241, s[44:47], s68 offen offset:1024 sc1
    buffer_load_dwordx3 v[200:202], v241, s[44:47], s68 offen offset:2048 sc1
    buffer_load_dwordx3 v[204:206], v241, s[44:47], s68 offen offset:3072 sc1
    buffer_load_dwordx3 v[208:210], v241, s[44:47], s69 offen sc1
    buffer_load_dwordx3 v[212:214], v241, s[44:47], s69 offen offset:1024 sc1
    buffer_load_dwordx3 v[216:218], v241, s[44:47], s69 offen offset:2048 sc1
    buffer_load_dwordx3 v[220:222], v241, s[44:47], s69 offen offset:3072 sc1
    s_mov_b64 exec, -1
    s_waitcnt vmcnt(8)
    v_bitop3_b32 v31, v178, v182, s6 bitop3:0x7e
    v_bitop3_b32 v31, v31, v186, s6 bitop3:0xf6
    v_bitop3_b32 v31, v31, v190, s6 bitop3:0xf6
    v_cmp_ne_u32 vcc, 0, v31
    s_cbranch_vccz RC_4
    s_waitcnt vmcnt(0)
    s_sub_u32 s7, s7, 1
    s_cbranch_scc0 FL_12
    s_branch RC_4
PAD_3:
    s_branch L_WRET
RC_5:
    s_mov_b32 s7, 20000
    s_waitcnt vmcnt(0)
FL_13:
    v_bitop3_b32 v31, v194, v198, s6 bitop3:0x7e
    v_bitop3_b32 v31, v31, v202, s6 bitop3:0xf6
    v_bitop3_b32 v31, v31, v206, s6 bitop3:0xf6
    v_bitop3_b32 v31, v31, v210, s6 bitop3:0xf6
    v_bitop3_b32 v31, v31, v214, s6 bitop3:0xf6
    v_bitop3_b32 v31, v31, v218, s6 bitop3:0xf6
    v_bitop3_b32 v31, v31, v222, s6 bitop3:0xf6
    v_cmp_ne_u32 vcc, 0, v31
    s_mov_b64 exec, vcc
    buffer_load_dwordx3 v[192:194], v241, s[44:47], s68 offen sc1
    buffer_load_dwordx3 v[196:198], v241, s[44:47], s68 offen offset:1024 sc1
    buffer_load_dwordx3 v[200:202], v241, s[44:47], s68 offen offset:2048 sc1
    buffer_load_dwordx3 v[204:206], v241, s[44:47], s68 offen offset:3072 sc1
    buffer_load_dwordx3 v[208:210], v241, s[44:47], s69 offen sc1
    buffer_load_dwordx3 v[212:214], v241, s[44:47], s69 offen offset:1024 sc1
    buffer_load_dwordx3 v[216:218], v241, s[44:47], s69 offen offset:2048 sc1
    buffer_load_dwordx3 v[220:222], v241, s[44:47], s69 offen offset:3072 sc1
    s_mov_b64 exec, -1
    s_waitcnt vmcnt(4)
    v_bitop3_b32 v31, v194, v198, s6 bitop3:0x7e
    v_bitop3_b32 v31, v31, v202, s6 bitop3:0xf6
    v_bitop3_b32 v31, v31, v206, s6 bitop3:0xf6
    v_cmp_ne_u32 vcc, 0, v31
    s_cbranch_vccz RC_6
    s_waitcnt vmcnt(0)
    s_sub_u32 s7, s7, 1
    s_cbranch_scc0 FL_13
    s_branch RC_6
PAD_4:
    s_branch L_WRET
RC_7:
    s_mov_b32 s7, 20000
    s_waitcnt vmcnt(0)
FL_14:
    v_bitop3_b32 v31, v210, v214, s6 bitop3:0x7e
    v_bitop3_b32 v31, v31, v218, s6 bitop3:0xf6
    v_bitop3_b32 v31, v31, v222, s6 bitop3:0xf6
    v_cmp_ne_u32 vcc, 0, v31
    s_mov_b64 exec, vcc
    buffer_load_dwordx3 v[208:210], v241, s[44:47], s69 offen sc1
    buffer_load_dwordx3 v[212:214], v241, s[44:47], s69 offen offset:1024 sc1
    buffer_load_dwordx3 v[216:218], v241, s[44:47], s69 offen offset:2048 sc1
    buffer_load_dwordx3 v[220:222], v241, s[44:47], s69 offen offset:3072 sc1
    s_mov_b64 exec, -1
    s_waitcnt vmcnt(0)
    v_bitop3_b32 v31, v210, v214, s6 bitop3:0x7e
    v_bitop3_b32 v31, v31, v218, s6 bitop3:0xf6
    v_bitop3_b32 v31, v31, v222, s6 bitop3:0xf6
    v_cmp_ne_u32 vcc, 0, v31
    s_cbranch_vccz RC_8
    s_waitcnt vmcnt(0)
    s_sub_u32 s7, s7, 1
    s_cbranch_scc0 FL_14
    s_branch RC_8
PAD_5:
    s_branch L_WRET
PAD_6:
    s_branch L_WRET
L_XS:
    s_mov_b32 s52, s18
    s_mov_b32 s53, s19
    s_mov_b32 s54, 0x1000000
    s_mov_b32 s55, 0x00020000
    s_lshl_b32 s8, s3, 4
    s_add_u32 s8, s8, s4
    s_lshl_b32 s66, s8, 17
    s_lshl_b32 s9, s5, 15
    s_add_u32 s66, s66, s9
    s_and_b32 s8, s4, 3
    s_xor_b32 s8, s8, s5
    s_lshl_b32 s8, s8, 8
    s_add_u32 s66, s66, s8
    s_add_u32 s67, s9, 32768
    v_lshlrev_b32 v22, 2, v3
    v_xor_b32 v21, v22, v2
    v_lshlrev_b32 v21, 4, v21
    v_lshl_add_u32 v21, v3, 10, v21
    v_xor_b32 v22, 16, v21
    v_add_u32 v22, 3072, v22
    v_xor_b32 v23, 32, v21
    v_add_u32 v23, 6144, v23
    v_xor_b32 v24, 48, v21
    v_add_u32 v24, 9216, v24
    s_waitcnt lgkmcnt(0)
    s_or_b32 s6, s99, 0x40004000
    s_add_u32 s6, s6, 1
    s_and_b32 s6, s6, 0xbfffbfff
    s_barrier
    s_mov_b32 s48, s24
    s_mov_b32 s49, s25
    s_mov_b32 s50, 0x400000
    s_mov_b32 s51, 0x00020000
    s_lshr_b32 s8, s4, 2
    s_lshl_b32 s64, s3, 2
    s_add_u32 s64, s64, s8
    s_and_b32 s65, s4, 3
    s_lshl_b32 s8, s65, 2
    s_add_u32 s8, s8, s5
    s_lshl_b32 s68, s8, 18
    s_lshl_b32 s8, s64, 8
    s_add_u32 s68, s68, s8
    v_lshlrev_b32 v25, 13, v3
    v_lshl_add_u32 v25, v2, 4, v25
    v_lshlrev_b32 v20, 4, v1
    v_and_b32 v30, 31, v1
    v_lshrrev_b32 v31, 5, v1
    v_and_b32 v26, 3, v2
    v_lshlrev_b32 v26, 2, v26
    v_lshrrev_b32 v27, 2, v2
    v_or_b32 v26, v26, v27
    v_xor_b32 v26, v26, v31
    v_lshlrev_b32 v26, 4, v26
    v_lshl_add_u32 v26, v30, 8, v26
    s_lshl_b32 s8, s5, 15
    s_add_u32 s8, s8, 32768
    v_add_u32 v240, s8, v26
    v_lshl_add_u32 v26, v30, 1, v31
    v_lshrrev_b32 v27, 3, v2
    v_xor_b32 v26, v26, v27
    v_lshlrev_b32 v26, 4, v26
    v_lshl_add_u32 v28, v27, 2, v3
    v_lshlrev_b32 v28, 7, v28
    v_and_b32 v27, 7, v2
    v_lshl_add_u32 v28, v27, 4, v28
    v_lshlrev_b32 v27, 2, v2
    v_lshlrev_b32 v29, 9, v3
    v_lshl_add_u32 v29, v2, 4, v29
    s_lshl_b32 s69, s3, 7
    s_add_u32 s69, s69, 8192
    s_mov_b32 s93, s6
    s_mov_b32 s92, 0x42700000
    s_lshl_b32 s70, s64, 11
    s_add_u32 s70, s70, 327680
    s_lshl_b32 s8, s3, 2
    s_add_u32 s8, s8, s65
    s_lshl_b32 s71, s8, 8
    s_lshr_b32 s9, s5, 1
    s_lshl_b32 s8, s9, 7
    s_add_u32 s71, s71, s8
    s_add_u32 s71, s71, 12288
    s_lshl_b32 s8, s3, 4
    s_add_u32 s8, s8, s4
    s_lshl_b32 s8, s8, 1
    s_add_u32 s8, s8, s9
    s_lshl_b32 s72, s8, 14
    s_and_b32 s8, s5, 1
    s_lshl_b32 s8, s8, 8
    s_add_u32 s72, s72, s8
    s_add_u32 s72, s72, 2097152
    s_add_u32 s73, s72, 4096
    s_add_u32 s74, s73, 4096
    s_add_u32 s75, s74, 4096
    s_lshl_b32 s8, s5, 13
    v_mov_b32 v248, s8
    v_add_u32 v26, s8, v26
    v_xor_b32 v14, 8192, v26
    v_xor_b32 v15, 16384, v26
    v_xor_b32 v16, 24576, v26
    v_mov_b32 v249, 1
    v_xor_b32 v241, 32, v240
    v_xor_b32 v242, 64, v240
    v_xor_b32 v243, 96, v240
    v_xor_b32 v244, 128, v240
    v_xor_b32 v245, 160, v240
    v_xor_b32 v246, 192, v240
    v_xor_b32 v247, 224, v240
    v_and_b32 v250, 31, v1
    v_lshlrev_b32 v250, 3, v250
    s_lshl_b32 s76, s3, 8
    s_add_u32 s76, s76, 4096
    s_branch PSK_31
PAD_31:
    s_branch L_WRET
PSK_31:
    s_mov_b32 m0, s67
    s_nop 0
    buffer_load_dwordx4 v21, s[52:55], s66 offen offset:0 nt lds
    buffer_load_dwordx4 v22, s[52:55], s66 offen offset:1024 nt lds
    s_waitcnt vmcnt(1)
    buffer_load_dwordx4 v23, s[52:55], s66 offen offset:2048 nt lds
    s_waitcnt vmcnt(1)
    buffer_load_dwordx4 v24, s[52:55], s66 offen offset:3072 nt lds
    s_add_u32 s67, s67, 4096
    s_xor_b32 s66, s66, 16384
    s_mov_b32 m0, s67
    s_nop 0
    buffer_load_dwordx4 v21, s[52:55], s66 offen offset:0 nt lds
    buffer_load_dwordx4 v22, s[52:55], s66 offen offset:1024 nt lds
    buffer_load_dwordx4 v23, s[52:55], s66 offen offset:2048 nt lds
    buffer_load_dwordx4 v24, s[52:55], s66 offen offset:3072 nt lds
    s_add_u32 s67, s67, 4096
    s_xor_b32 s66, s66, 16640
    s_mov_b32 m0, s67
    s_nop 0
    buffer_load_dwordx4 v21, s[52:55], s66 offen offset:0 nt lds
    s_xor_b32 s8, s72, 0x8000
    buffer_load_dwordx3 v[128:130], v28, s[44:47], s70 offen sc1
    buffer_load_dwordx3 v[132:134], v28, s[44:47], s70 offen offset:1024 sc1
    buffer_load_dword v136, v27, s[44:47], s71 offen sc1
    buffer_load_dword v140, v27, s[44:47], s8 offen sc1
    buffer_load_dwordx4 v22, s[52:55], s66 offen offset:1024 nt lds
    s_waitcnt vmcnt(11)
    buffer_load_dwordx4 v23, s[52:55], s66 offen offset:2048 nt lds
    buffer_load_dword v192, v27, s[44:47], s69 offen sc1
    s_waitcnt vmcnt(12)
    buffer_load_dwordx4 v24, s[52:55], s66 offen offset:3072 nt lds
    s_add_u32 s67, s67, 4096
    s_xor_b32 s66, s66, 16384
    s_waitcnt vmcnt(12)
    s_mov_b32 m0, s67
    s_nop 0
    buffer_load_dwordx4 v21, s[52:55], s66 offen offset:0 nt lds
    buffer_load_dword v193, v27, s[44:47], s69 offen sc1
    s_waitcnt vmcnt(13)
    buffer_load_dwordx4 v22, s[52:55], s66 offen offset:1024 nt lds
    buffer_load_dwordx2 v[252:253], v250, s[44:47], s76 offen sc1
    s_waitcnt vmcnt(14)
    buffer_load_dwordx4 v23, s[52:55], s66 offen offset:2048 nt lds
    buffer_load_dword v194, v27, s[44:47], s69 offen sc1
    s_waitcnt vmcnt(15)
    ds_read_b128 v[208:211], v240 offset:0
    ds_read_b128 v[224:227], v241 offset:0
    ds_read_b128 v[32:35], v242 offset:0
    ds_read_b128 v[48:51], v243 offset:0
    ds_read_b128 v[64:67], v244 offset:0
    ds_read_b128 v[80:83], v245 offset:0
    ds_read_b128 v[96:99], v246 offset:0
    ds_read_b128 v[112:115], v247 offset:0
    buffer_load_dwordx4 v24, s[52:55], s66 offen offset:3072 nt lds
    s_add_u32 s67, s67, 4096
    s_xor_b32 s66, s66, 17152
    s_waitcnt vmcnt(15)
    s_mov_b32 m0, s67
    s_nop 0
    buffer_load_dwordx4 v21, s[52:55], s66 offen offset:0 nt lds
    buffer_load_dword v195, v27, s[44:47], s69 offen sc1
    s_waitcnt vmcnt(12)
    buffer_load_dwordx4 v22, s[52:55], s66 offen offset:1024 nt lds
    s_waitcnt vmcnt(12)
    buffer_load_dwordx4 v23, s[52:55], s66 offen offset:2048 nt lds
    s_waitcnt vmcnt(7)
    s_getreg_b32 s9, hwreg(HW_REG_XCC_ID, 0, 4)
    v_xor_b32 v252, s9, v252
    v_xor_b32 v253, s6, v253
    v_or_b32 v252, v252, v253
    v_cmp_ne_u32 vcc, 0, v252
    s_cmp_eq_u64 vcc, 0
    s_cselect_b32 s98, 1, 0
    s_cmp_lg_u32 s5, 0
    s_cbranch_scc1 L_XKF
    s_lshl_b32 s8, s4, 2
    s_add_u32 s8, s8, s69
    v_mov_b32 v251, s6
    s_cmp_eq_u32 s98, 0
    s_cbranch_scc1 SL_15
    s_mov_b32 exec_lo, 0x1
    s_mov_b32 exec_hi, 0x0
    buffer_store_dword v251, v20, s[44:47], s8 offen offset:1024
SL_16:
    s_mov_b64 exec, -1
L_XKF:
    buffer_load_dword v196, v27, s[44:47], s69 offen sc1
    v_cmp_ne_u32 vcc, s93, v193
    s_cbranch_vccnz HS_17
    ds_write_b32 v248, v249 offset:6144
    s_not_b32 s93, s93
HS_17:
    buffer_load_dwordx4 v24, s[52:55], s66 offen offset:3072 nt lds
    s_add_u32 s67, s67, 4096
    s_xor_b32 s66, s66, 16384
    s_mov_b32 m0, s67
    s_nop 0
    buffer_load_dwordx4 v21, s[52:55], s66 offen offset:0 nt lds
    buffer_load_dword v197, v27, s[44:47], s69 offen sc1
    buffer_load_dwordx4 v22, s[52:55], s66 offen offset:1024 nt lds
    s_waitcnt vmcnt(11)
    buffer_load_dwordx4 v23, s[52:55], s66 offen offset:2048 nt lds
    buffer_load_dword v198, v27, s[44:47], s69 offen sc1
    s_waitcnt vmcnt(11)
    ds_read_b128 v[212:215], v240 offset:8192
    ds_read_b128 v[228:231], v241 offset:8192
    ds_read_b128 v[36:39], v242 offset:8192
    ds_read_b128 v[52:55], v243 offset:8192
    ds_read_b128 v[68:71], v244 offset:8192
    ds_read_b128 v[84:87], v245 offset:8192
    s_waitcnt lgkmcnt(14)
    ds_read_b128 v[100:103], v246 offset:8192
    s_waitcnt lgkmcnt(14)
    ds_read_b128 v[116:119], v247 offset:8192
    v_cmp_ne_u32 vcc, s93, v194
    s_cbranch_vccnz HS_18
    ds_write_b32 v248, v249 offset:6144
    s_not_b32 s93, s93
HS_18:
    buffer_load_dwordx4 v24, s[52:55], s66 offen offset:3072 nt lds
    s_add_u32 s67, s67, 4096
    s_xor_b32 s66, s66, 16640
    s_waitcnt vmcnt(11)
    s_mov_b32 m0, s67
    s_nop 0
    buffer_load_dwordx4 v21, s[52:55], s66 offen offset:0 nt lds
    buffer_load_dword v199, v27, s[44:47], s69 offen sc1
    s_waitcnt vmcnt(11)
    v_cmp_ne_u32 vcc, s93, v195
    s_cbranch_vccnz HS_19
    ds_write_b32 v248, v249 offset:6144
    s_not_b32 s93, s93
HS_19:
    buffer_load_dwordx4 v22, s[52:55], s66 offen offset:1024 nt lds
    s_waitcnt vmcnt(11)
    buffer_load_dwordx4 v23, s[52:55], s66 offen offset:2048 nt lds
    buffer_load_dword v192, v27, s[44:47], s69 offen sc1
    s_waitcnt vmcnt(11)
    v_cmp_ne_u32 vcc, s93, v196
    s_cbranch_vccnz HS_20
    ds_write_b32 v248, v249 offset:6144
    s_not_b32 s93, s93
HS_20:
    buffer_load_dwordx4 v24, s[52:55], s66 offen offset:3072 nt lds
    s_add_u32 s67, s67, 4096
    s_xor_b32 s66, s66, 16384
    s_waitcnt vmcnt(11)
    s_mov_b32 m0, s67
    s_nop 0
    buffer_load_dwordx4 v21, s[52:55], s66 offen offset:0 nt lds
    buffer_load_dword v193, v27, s[44:47], s69 offen sc1
    s_waitcnt vmcnt(11)
    v_cmp_ne_u32 vcc, s93, v197
    s_cbranch_vccnz HS_21
    ds_write_b32 v248, v249 offset:6144
    s_not_b32 s93, s93
HS_21:
    buffer_load_dwordx4 v22, s[52:55], s66 offen offset:1024 nt lds
    s_waitcnt vmcnt(11)
    buffer_load_dwordx4 v23, s[52:55], s66 offen offset:2048 nt lds
    buffer_load_dword v194, v27, s[44:47], s69 offen sc1
    s_waitcnt vmcnt(11)
    s_waitcnt lgkmcnt(14)
    ds_read_b128 v[216:219], v240 offset:16384
    s_waitcnt lgkmcnt(14)
    ds_read_b128 v[232:235], v241 offset:16384
    s_waitcnt lgkmcnt(2)
    ds_read_b128 v[40:43], v242 offset:16384
    ds_read_b128 v[56:59], v243 offset:16384
    ds_read_b128 v[72:75], v244 offset:16384
    ds_read_b128 v[88:91], v245 offset:16384
    ds_read_b128 v[104:107], v246 offset:16384
    ds_read_b128 v[120:123], v247 offset:16384
    v_cmp_ne_u32 vcc, s93, v198
    s_cbranch_vccnz HS_22
    ds_write_b32 v248, v249 offset:6144
    s_not_b32 s93, s93
HS_22:
    buffer_load_dwordx4 v24, s[52:55], s66 offen offset:3072 nt lds
    s_barrier
    s_cmp_lg_u32 s93, s6
    s_cbranch_scc1 L_XSGO
    s_waitcnt vmcnt(10)
    v_cmp_ne_u32 vcc, s93, v199
    s_cbranch_vccnz HS_23
    ds_write_b32 v248, v249 offset:6144
    s_not_b32 s93, s93
HS_23:
    s_cmp_lg_u32 s93, s6
    s_cbranch_scc1 L_XSGO
    s_waitcnt vmcnt(7)
    v_cmp_ne_u32 vcc, s93, v192
    s_cbranch_vccnz HS_24
    ds_write_b32 v248, v249 offset:6144
    s_not_b32 s93, s93
HS_24:
    s_cmp_lg_u32 s93, s6
    s_cbranch_scc1 L_XSGO
    s_waitcnt vmcnt(4)
    v_cmp_ne_u32 vcc, s93, v193
    s_cbranch_vccnz HS_25
    ds_write_b32 v248, v249 offset:6144
    s_not_b32 s93, s93
HS_25:
    s_cmp_lg_u32 s93, s6
    s_cbranch_scc1 L_XSGO
    s_waitcnt vmcnt(1)
    v_cmp_ne_u32 vcc, s93, v194
    s_cbranch_vccnz HS_26
    ds_write_b32 v248, v249 offset:6144
    s_not_b32 s93, s93
HS_26:
    s_cmp_lg_u32 s93, s6
    s_cbranch_scc1 L_XSGO
    s_mov_b32 s7, 20000
PL_27:
    buffer_load_dword v192, v27, s[44:47], s69 offen sc1
    s_waitcnt vmcnt(0)
    v_cmp_ne_u32 vcc, s6, v192
    s_cbranch_vccz PD_28
    s_sub_u32 s7, s7, 1
    s_cbranch_scc0 PL_27
    s_branch PD_28
PAD_7:
    s_branch L_WRET
PD_28:
    ds_write_b32 v248, v249 offset:6144
L_XSGO:
    s_waitcnt lgkmcnt(0)
    s_waitcnt vmcnt(0)
    ds_read_b128 v[220:223], v240 offset:24576
    ds_read_b128 v[236:239], v241 offset:24576
    ds_read_b128 v[44:47], v242 offset:24576
    ds_read_b128 v[60:63], v243 offset:24576
    ds_read_b128 v[76:79], v244 offset:24576
    ds_read_b128 v[92:95], v245 offset:24576
    ds_read_b128 v[108:111], v246 offset:24576
    ds_read_b128 v[124:127], v247 offset:24576
    s_barrier
    s_barrier
    ds_read_b128 v[160:163], v26 offset:0
    ds_read_b128 v[164:167], v26 offset:1024
    ds_read_b128 v[168:171], v14 offset:0
    ds_read_b128 v[172:175], v14 offset:1024
    ds_read_b128 v[176:179], v15 offset:0
    ds_read_b128 v[180:183], v15 offset:1024
    ds_read_b128 v[184:187], v16 offset:0
    s_waitcnt lgkmcnt(14)
    ds_read_b128 v[188:191], v16 offset:1024
    s_waitcnt lgkmcnt(7)
    v_mfma_f32_32x32x16_bf16 v[192:207], v[208:211], v[160:163], 0
    s_waitcnt lgkmcnt(6)
    v_mfma_f32_32x32x16_bf16 v[192:207], v[224:227], v[164:167], v[192:207]
    s_barrier
    ds_read_b128 v[128:131], v26 offset:2048
    ds_read_b128 v[132:135], v26 offset:3072
    ds_read_b128 v[136:139], v14 offset:2048
    ds_read_b128 v[140:143], v14 offset:3072
    ds_read_b128 v[144:147], v15 offset:2048
    ds_read_b128 v[148:151], v15 offset:3072
    ds_read_b128 v[152:155], v16 offset:2048
    ds_read_b128 v[156:159], v16 offset:3072
    s_waitcnt lgkmcnt(13)
    v_mfma_f32_32x32x16_bf16 v[192:207], v[212:215], v[168:171], v[192:207]
    s_waitcnt lgkmcnt(12)
    v_mfma_f32_32x32x16_bf16 v[192:207], v[228:231], v[172:175], v[192:207]
    s_waitcnt lgkmcnt(11)
    v_mfma_f32_32x32x16_bf16 v[192:207], v[216:219], v[176:179], v[192:207]
    s_waitcnt lgkmcnt(10)
    v_mfma_f32_32x32x16_bf16 v[192:207], v[232:235], v[180:183], v[192:207]
    s_waitcnt lgkmcnt(9)
    v_mfma_f32_32x32x16_bf16 v[192:207], v[220:223], v[184:187], v[192:207]
    s_waitcnt lgkmcnt(8)
    v_mfma_f32_32x32x16_bf16 v[192:207], v[236:239], v[188:191], v[192:207]
    s_waitcnt lgkmcnt(7)
    v_mfma_f32_32x32x16_bf16 v[192:207], v[32:35], v[128:131], v[192:207]
    buffer_load_dwordx2 v[252:253], v250, s[44:47], s76 offen sc1
    buffer_load_dwordx4 v[208:211], v25, s[48:51], s68 offen nt
    s_add_u32 s68, s68, 0x8000
    s_waitcnt lgkmcnt(6)
    v_mfma_f32_32x32x16_bf16 v[192:207], v[48:51], v[132:135], v[192:207]
    buffer_load_dwordx4 v[212:215], v25, s[48:51], s68 offen nt
    s_add_u32 s68, s68, 0x8000
    s_barrier
    ds_read_b128 v[160:163], v26 offset:4096
    ds_read_b128 v[164:167], v26 offset:5120
    ds_read_b128 v[168:171], v14 offset:4096
    ds_read_b128 v[172:175], v14 offset:5120
    ds_read_b128 v[176:179], v15 offset:4096
    ds_read_b128 v[180:183], v15 offset:5120
    ds_read_b128 v[184:187], v16 offset:4096
    ds_read_b128 v[188:191], v16 offset:5120
    s_waitcnt lgkmcnt(13)
    v_mfma_f32_32x32x16_bf16 v[192:207], v[36:39], v[136:139], v[192:207]
    buffer_load_dwordx4 v[216:219], v25, s[48:51], s68 offen nt
    s_add_u32 s68, s68, 0x8000
    s_waitcnt lgkmcnt(12)
    v_mfma_f32_32x32x16_bf16 v[192:207], v[52:55], v[140:143], v[192:207]
    buffer_load_dwordx4 v[220:223], v25, s[48:51], s68 offen nt
    s_add_u32 s68, s68, 0x8000
    s_waitcnt lgkmcnt(11)
    v_mfma_f32_32x32x16_bf16 v[192:207], v[40:43], v[144:147], v[192:207]
    buffer_load_dwordx4 v[224:227], v25, s[48:51], s68 offen nt
    s_add_u32 s68, s68, 0x8000
    s_waitcnt lgkmcnt(10)
    v_mfma_f32_32x32x16_bf16 v[192:207], v[56:59], v[148:151], v[192:207]
    buffer_load_dwordx4 v[228:231], v25, s[48:51], s68 offen nt
    s_add_u32 s68, s68, 0x8000
    s_waitcnt lgkmcnt(9)
    v_mfma_f32_32x32x16_bf16 v[192:207], v[44:47], v[152:155], v[192:207]
    buffer_load_dwordx4 v[232:235], v25, s[48:51], s68 offen nt
    s_add_u32 s68, s68, 0x8000
    s_waitcnt lgkmcnt(8)
    v_mfma_f32_32x32x16_bf16 v[192:207], v[60:63], v[156:159], v[192:207]
    buffer_load_dwordx4 v[236:239], v25, s[48:51], s68 offen nt
    s_waitcnt lgkmcnt(7)
    v_mfma_f32_32x32x16_bf16 v[192:207], v[64:67], v[160:163], v[192:207]
    s_lshl_b32 s8, s5, 2
    v_add_u32 v21, s8, v20
    s_lshl_b32 s9, s5, 10
    v_add_u32 v22, s9, v20
    v_and_b32 v30, 31, v1
    v_lshrrev_b32 v31, 5, v1
    v_lshlrev_b32 v23, 5, v30
    v_lshl_add_u32 v23, v31, 4, v23
    v_add_u32 v23, s8, v23
    v_mov_b32 v24, 0
    v_mov_b32 v251, 0x3f803f80
    s_waitcnt lgkmcnt(6)
    v_mfma_f32_32x32x16_bf16 v[192:207], v[80:83], v[164:167], v[192:207]
    s_branch PSK_32
PAD_32:
    s_branch L_WRET
PSK_32:
    s_barrier
    ds_read_b128 v[128:131], v26 offset:6144
    ds_read_b128 v[132:135], v26 offset:7168
    ds_read_b128 v[136:139], v14 offset:6144
    ds_read_b128 v[140:143], v14 offset:7168
    ds_read_b128 v[144:147], v15 offset:6144
    ds_read_b128 v[148:151], v15 offset:7168
    ds_read_b128 v[152:155], v16 offset:6144
    ds_read_b128 v[156:159], v16 offset:7168
    s_waitcnt lgkmcnt(13)
    v_mfma_f32_32x32x16_bf16 v[192:207], v[68:71], v[168:171], v[192:207]
    s_waitcnt lgkmcnt(12)
    v_mfma_f32_32x32x16_bf16 v[192:207], v[84:87], v[172:175], v[192:207]
    s_waitcnt lgkmcnt(11)
    v_mfma_f32_32x32x16_bf16 v[192:207], v[72:75], v[176:179], v[192:207]
    s_waitcnt lgkmcnt(10)
    v_mfma_f32_32x32x16_bf16 v[192:207], v[88:91], v[180:183], v[192:207]
    s_waitcnt lgkmcnt(9)
    v_mfma_f32_32x32x16_bf16 v[192:207], v[76:79], v[184:187], v[192:207]
    s_waitcnt lgkmcnt(8)
    v_mfma_f32_32x32x16_bf16 v[192:207], v[92:95], v[188:191], v[192:207]
    s_waitcnt lgkmcnt(7)
    v_mfma_f32_32x32x16_bf16 v[192:207], v[96:99], v[128:131], v[192:207]
    s_waitcnt lgkmcnt(6)
    v_mfma_f32_32x32x16_bf16 v[192:207], v[112:115], v[132:135], v[192:207]
    s_waitcnt lgkmcnt(5)
    v_mfma_f32_32x32x16_bf16 v[192:207], v[100:103], v[136:139], v[192:207]
    s_waitcnt lgkmcnt(4)
    v_mfma_f32_32x32x16_bf16 v[192:207], v[116:119], v[140:143], v[192:207]
    s_waitcnt lgkmcnt(3)
    v_mfma_f32_32x32x16_bf16 v[192:207], v[104:107], v[144:147], v[192:207]
    s_waitcnt lgkmcnt(2)
    v_mfma_f32_32x32x16_bf16 v[192:207], v[120:123], v[148:151], v[192:207]
    s_waitcnt lgkmcnt(1)
    v_mfma_f32_32x32x16_bf16 v[192:207], v[108:111], v[152:155], v[192:207]
    s_waitcnt lgkmcnt(0)
    v_mfma_f32_32x32x16_bf16 v[192:207], v[124:127], v[156:159], v[192:207]
    s_nop 11
    v_max3_f32 v88, v192, v193, v194
    v_max3_f32 v89, v195, v196, v197
    v_max3_f32 v90, v198, v199, v200
    v_max3_f32 v91, v201, v202, v203
    v_max3_f32 v92, v204, v205, v206
    v_max3_f32 v88, v88, v89, v207
    v_max3_f32 v90, v90, v91, v92
    v_max_f32 v88, v88, v90
    ds_write_b32 v21, v88 offset:40960
L_XSM:
    v_exp_f32 v64, v192
    v_exp_f32 v65, v193
    v_exp_f32 v66, v194
    v_exp_f32 v67, v195
    v_cvt_pk_bf16_f32 v80, v64, v65
    v_exp_f32 v68, v196
    v_exp_f32 v69, v197
    v_cvt_pk_bf16_f32 v81, v66, v67
    v_exp_f32 v70, v198
    v_exp_f32 v71, v199
    v_cvt_pk_bf16_f32 v82, v68, v69
    v_cvt_pk_bf16_f32 v83, v70, v71
    ds_write_b128 v22, v[80:83] offset:32768
    v_exp_f32 v72, v200
    v_exp_f32 v73, v201
    v_exp_f32 v74, v202
    v_exp_f32 v75, v203
    v_cvt_pk_bf16_f32 v84, v72, v73
    v_exp_f32 v76, v204
    v_exp_f32 v77, v205
    v_cvt_pk_bf16_f32 v85, v74, v75
    v_exp_f32 v78, v206
    v_exp_f32 v79, v207
    v_cvt_pk_bf16_f32 v86, v76, v77
    v_cvt_pk_bf16_f32 v87, v78, v79
    ds_write_b128 v22, v[84:87] offset:36864
    s_waitcnt lgkmcnt(0)
    s_barrier
    ds_read_b128 v[88:91], v20 offset:40960
    v_mov_b32 v30, 0
    v_mov_b32 v31, 0
    v_dot2_f32_bf16 v30, v80, v251, v30
    v_dot2_f32_bf16 v31, v81, v251, v31
    v_dot2_f32_bf16 v30, v82, v251, v30
    v_dot2_f32_bf16 v31, v83, v251, v31
    v_dot2_f32_bf16 v30, v84, v251, v30
    v_dot2_f32_bf16 v31, v85, v251, v31
    v_dot2_f32_bf16 v30, v86, v251, v30
    v_dot2_f32_bf16 v31, v87, v251, v31
    s_nop 2
    v_add_f32 v30, v30, v31
    s_waitcnt lgkmcnt(0)
    v_max3_f32 v31, |v88|, |v89|, |v90|
    v_max_f32_e64 v31, |v91|, v31
    v_cmp_lt_f32 vcc, s92, v31
    s_cbranch_vccnz L_XSSLOW
    ds_write_b32 v23, v30 offset:41984
    s_waitcnt lgkmcnt(0)
    s_barrier
    s_waitcnt vmcnt(8)
    s_getreg_b32 s9, hwreg(HW_REG_XCC_ID, 0, 4)
    v_xor_b32 v252, s9, v252
    v_xor_b32 v253, s6, v253
    v_or_b32 v252, v252, v253
    v_cmp_ne_u32 vcc, 0, v252
    s_cmp_eq_u64 vcc, 0
    s_cselect_b32 s98, 1, 0
    s_cmp_lg_u32 s5, 3
    s_cbranch_scc1 L_XRD
    v_and_b32 v30, 31, v1
    v_lshlrev_b32 v31, 5, v30
    ds_read_b128 v[64:67], v31 offset:41984
    ds_read_b128 v[68:71], v31 offset:42000
    v_lshrrev_b32 v31, 4, v30
    v_bfe_u32 v21, v30, 2, 1
    v_lshl_add_u32 v31, v31, 1, v21
    v_lshlrev_b32 v31, 11, v31
    v_bfe_u32 v21, v30, 3, 1
    v_lshl_add_u32 v31, v21, 6, v31
    v_and_b32 v21, 3, v30
    v_lshl_add_u32 v31, v21, 4, v31
    s_lshl_b32 s8, s3, 13
    s_lshl_b32 s9, s4, 7
    s_add_u32 s8, s8, s9
    s_add_u32 s8, s8, 327680
    v_mov_b32 v72, v24
    v_mov_b32 v74, s6
    v_mov_b32 v75, s6
    s_waitcnt lgkmcnt(0)
    v_pk_add_f32 v[64:65], v[64:65], v[66:67]
    v_pk_add_f32 v[68:69], v[68:69], v[70:71]
    v_pk_add_f32 v[64:65], v[64:65], v[68:69]
    v_add_f32 v73, v64, v65
    s_cmp_eq_u32 s98, 0
    s_cbranch_scc1 SL_29
    s_mov_b32 exec_lo, 0xffffffff
    s_mov_b32 exec_hi, 0x0
    buffer_store_dwordx4 v[72:75], v31, s[44:47], s8 offen
SL_30:
    s_mov_b64 exec, -1
L_XRD:
    v_and_b32 v30, 4, v2
    v_add_u32 v30, v30, v2
    v_lshlrev_b32 v22, 7, v30
    v_lshlrev_b32 v21, 14, v30
    v_lshl_add_u32 v21, v3, 4, v21
    s_lshr_b32 s8, s4, 3
    s_lshl_b32 s8, s8, 4
    s_and_b32 s9, s4, 4
    s_add_u32 s8, s8, s9
    s_lshl_b32 s77, s8, 14
    s_lshl_b32 s79, s8, 7
    s_lshr_b32 s8, s5, 1
    s_lshl_b32 s8, s8, 3
    s_add_u32 s8, s8, s65
    s_lshl_b32 s8, s8, 1
    s_and_b32 s9, s5, 1
    s_add_u32 s8, s8, s9
    s_lshl_b32 s8, s8, 9
    s_add_u32 s77, s77, s8
    s_lshl_b32 s8, s3, 6
    s_add_u32 s77, s77, s8
    s_add_u32 s77, s77, 1048576
    s_add_u32 s78, s77, 4096
    s_and_b32 s8, s3, 3
    s_lshl_b32 s8, s8, 1
    s_lshr_b32 s9, s3, 2
    s_add_u32 s8, s8, s9
    s_lshl_b32 s8, s8, 4
    s_add_u32 s79, s79, s8
    s_add_u32 s79, s79, 393216
    s_or_b32 s80, s5, s65
    v_mov_b32 v106, s6
    v_mov_b32 v107, s6
    v_mov_b32 v110, s6
    v_mov_b32 v111, s6
    v_mov_b32 v114, s6
    v_mov_b32 v115, s6
    s_mov_b32 s7, 20000
AL_31:
    buffer_load_dwordx3 v[128:130], v28, s[44:47], s70 offen sc1
    buffer_load_dwordx3 v[132:134], v28, s[44:47], s70 offen offset:1024 sc1
    s_waitcnt vmcnt(0)
    v_bitop3_b32 v31, v130, v134, s6 bitop3:0x7e
    v_cmp_ne_u32 vcc, 0, v31
AW_33:
    s_cmp_eq_u64 exec, -1
    s_cselect_b64 s[94:95], -1, 0
    s_andn2_b64 s[94:95], s[94:95], vcc
    s_cmp_eq_u64 s[94:95], -1
    s_cbranch_scc1 AD_32
    s_ff1_i32_b64 s94, vcc
    s_lshl_b64 s[94:95], 1, s94
    s_cmp_eq_u64 vcc, 0
    s_cselect_b64 exec, -1, s[94:95]
    s_sub_u32 s7, s7, 1
    s_cbranch_scc0 AL_31
    s_mov_b64 exec, -1
    s_branch AD_32
PAD_8:
    s_branch L_WRET
AD_32:
    v_max_f32 v112, v128, v132
    s_nop 1
    v_max_f32_dpp v112, v112, v112 row_ror:8 row_mask:0xf bank_mask:0xf
    v_mov_b32 v31, v112
    s_nop 1
    v_permlane16_swap_b32 v112, v31
    v_max_f32 v112, v112, v31
    v_mov_b32 v31, v112
    s_nop 1
    v_permlane32_swap_b32 v112, v31
    v_max_f32 v112, v112, v31
    v_subrev_f32 v30, 0x42fe0000, v112
    v_mov_b32 v113, 0
    v_sub_f32 v31, v128, v30
    v_max_f32 v31, 0, v31
    v_cvt_u32_f32 v31, v31
    v_lshlrev_b32 v23, 23, v31
    v_fmac_f32 v113, v23, v129
    v_lshl_or_b32 v23, v31, 7, v23
    v_and_b32 v32, v23, v4
    v_and_b32 v33, v23, v5
    v_and_b32 v34, v23, v6
    v_and_b32 v35, v23, v7
    v_and_b32_dpp v36, v23, v4 row_ror:8 row_mask:0xf bank_mask:0xf
    v_and_b32_dpp v37, v23, v5 row_ror:8 row_mask:0xf bank_mask:0xf
    v_and_b32_dpp v38, v23, v6 row_ror:8 row_mask:0xf bank_mask:0xf
    v_and_b32_dpp v39, v23, v7 row_ror:8 row_mask:0xf bank_mask:0xf
    v_sub_f32 v31, v132, v30
    v_max_f32 v31, 0, v31
    v_cvt_u32_f32 v31, v31
    v_lshlrev_b32 v23, 23, v31
    v_fmac_f32 v113, v23, v133
    v_lshl_or_b32 v23, v31, 7, v23
    v_and_b32 v40, v23, v4
    v_and_b32 v41, v23, v5
    v_and_b32 v42, v23, v6
    v_and_b32 v43, v23, v7
    v_and_b32_dpp v44, v23, v4 row_ror:8 row_mask:0xf bank_mask:0xf
    v_and_b32_dpp v45, v23, v5 row_ror:8 row_mask:0xf bank_mask:0xf
    v_and_b32_dpp v46, v23, v6 row_ror:8 row_mask:0xf bank_mask:0xf
    v_and_b32_dpp v47, v23, v7 row_ror:8 row_mask:0xf bank_mask:0xf
    s_cmp_lg_u32 s80, 0
    s_cbranch_scc1 L_XRD2
    v_add_f32_dpp v113, v113, v113 row_ror:8 row_mask:0xf bank_mask:0xf
    v_mov_b32 v31, v113
    s_nop 1
    v_permlane16_swap_b32 v113, v31
    v_add_f32 v113, v113, v31
    v_mov_b32 v31, v113
    s_nop 1
    v_permlane32_swap_b32 v113, v31
    v_add_f32 v113, v113, v31
    s_mov_b32 exec_lo, 0xff
    s_mov_b32 exec_hi, 0x0
    buffer_store_dwordx4 v[112:115], v22, s[44:47], s79 offen sc1
    s_mov_b64 exec, -1
L_XRD2:
    s_mov_b32 exec_lo, 0xffff
    s_mov_b32 exec_hi, 0x0
    s_mov_b32 s7, 20000
PL_34:
    buffer_load_dword v136, v27, s[44:47], s71 offen sc1
    s_waitcnt vmcnt(0)
    v_cmp_ne_u32 vcc, s6, v136
    s_cbranch_vccz PD_35
    s_sub_u32 s7, s7, 1
    s_cbranch_scc0 PL_34
    s_branch PD_35
PAD_9:
    s_branch L_WRET
PD_35:
    s_mov_b64 exec, -1
    buffer_load_dwordx4 v[64:67], v29, s[44:47], s72 offen sc1 nt
    buffer_load_dwordx4 v[68:71], v29, s[44:47], s72 offen offset:2048 sc1 nt
    buffer_load_dwordx4 v[72:75], v29, s[44:47], s73 offen sc1 nt
    buffer_load_dwordx4 v[76:79], v29, s[44:47], s73 offen offset:2048 sc1 nt
    buffer_load_dwordx4 v[80:83], v29, s[44:47], s74 offen sc1 nt
    buffer_load_dwordx4 v[84:87], v29, s[44:47], s74 offen offset:2048 sc1 nt
    buffer_load_dwordx4 v[88:91], v29, s[44:47], s75 offen sc1 nt
    buffer_load_dwordx4 v[92:95], v29, s[44:47], s75 offen offset:2048 sc1 nt
    v_and_b32 v30, 1, v2
    v_lshl_add_u32 v22, v3, 1, v30
    v_lshlrev_b32 v22, 4, v22
    v_and_b32 v30, 12, v2
    v_add_u32 v30, v30, v3
    v_and_b32 v31, 3, v2
    v_lshl_add_u32 v23, v30, 2, v31
    v_lshlrev_b32 v23, 4, v23
    s_lshl_b32 s8, s64, 7
    s_add_u32 s10, s8, 393216
    s_lshl_b32 s8, s64, 2
    s_add_u32 s8, s8, s65
    s_lshl_b32 s12, s8, 9
    s_add_u32 s12, s12, 409600
    s_lshl_b32 s8, s8, 2
    s_add_u32 s8, s8, s5
    s_lshl_b32 s11, s8, 10
    s_add_u32 s11, s11, 1048576
    s_waitcnt vmcnt(7)
    v_mfma_f32_16x16x32_bf16 v[96:99], v[64:67], v[32:35], 0
    s_waitcnt vmcnt(6)
    v_mfma_f32_16x16x32_bf16 v[96:99], v[68:71], v[36:39], v[96:99]
    s_waitcnt vmcnt(5)
    v_mfma_f32_16x16x32_bf16 v[96:99], v[72:75], v[40:43], v[96:99]
    s_waitcnt vmcnt(4)
    v_mfma_f32_16x16x32_bf16 v[96:99], v[76:79], v[44:47], v[96:99]
    s_waitcnt vmcnt(3)
    v_mfma_f32_16x16x32_bf16 v[100:103], v[80:83], v[32:35], 0
    s_waitcnt vmcnt(2)
    v_mfma_f32_16x16x32_bf16 v[100:103], v[84:87], v[36:39], v[100:103]
    s_waitcnt vmcnt(1)
    v_mfma_f32_16x16x32_bf16 v[100:103], v[88:91], v[40:43], v[100:103]
    s_waitcnt vmcnt(0)
    v_mfma_f32_16x16x32_bf16 v[100:103], v[92:95], v[44:47], v[100:103]
    s_mov_b32 exec_lo, 0xff00ff
    s_mov_b32 exec_hi, 0xff00ff
    v_cvt_pk_bf16_f32 v104, v96, v97
    v_cvt_pk_bf16_f32 v105, v98, v99
    buffer_store_dwordx4 v[104:107], v21, s[44:47], s77 offen sc1
    s_nop 2
    v_cvt_pk_bf16_f32 v108, v100, v101
    v_cvt_pk_bf16_f32 v109, v102, v103
    buffer_store_dwordx4 v[108:111], v21, s[44:47], s78 offen sc1
    s_mov_b64 exec, -1
    s_barrier
    buffer_load_dwordx3 v[76:78], v22, s[44:47], s10 offen sc1
    buffer_load_dwordx3 v[72:74], v23, s[44:47], s11 offen sc1
    s_mul_i32 s8, s5, 528
    v_and_b32 v30, 1, v3
    v_lshlrev_b32 v30, 4, v30
    v_lshl_add_u32 v26, v2, 5, v30
    v_lshrrev_b32 v30, 1, v3
    v_lshl_add_u32 v26, v30, 3, v26
    v_add_u32 v26, s8, v26
    v_lshrrev_b32 v25, 1, v1
    v_lshlrev_b32 v25, 4, v25
    v_and_b32 v24, 1, v1
    v_mul_u32_u24 v24, 528, v24
    v_add_u32 v24, v24, v25
    s_waitcnt vmcnt(1)
    v_cmp_ne_u32 vcc, s6, v78
    s_cbranch_vccnz RC_36
RC_37:
    v_max_f32_dpp v48, v76, v76 quad_perm:[1,0,3,2] row_mask:0xf bank_mask:0xf
    v_mov_b32 v49, v48
    s_nop 1
    v_permlane16_swap_b32 v48, v49
    v_max_f32 v48, v48, v49
    v_mov_b32 v49, v48
    s_nop 1
    v_permlane32_swap_b32 v48, v49
    v_max_f32 v48, v48, v49
    v_subrev_f32 v48, 0x42fe0000, v48
    v_sub_f32 v49, v76, v48
    v_max_f32 v49, 0, v49
    v_cvt_u32_f32 v49, v49
    v_lshlrev_b32 v50, 23, v49
    v_mul_f32 v77, v50, v77
    v_lshl_or_b32 v50, v49, 7, v50
    v_and_b32 v56, v50, v18
    v_and_b32 v57, v50, v19
    v_add_f32_dpp v60, v77, v77 quad_perm:[1,0,3,2] row_mask:0xf bank_mask:0xf
    v_mov_b32 v49, v60
    s_nop 1
    v_permlane16_swap_b32 v60, v49
    v_add_f32 v60, v60, v49
    v_mov_b32 v49, v60
    s_nop 1
    v_permlane32_swap_b32 v60, v49
    v_add_f32 v60, v60, v49
    v_rcp_f32 v60, v60
    s_waitcnt vmcnt(0)
    v_cmp_ne_u32 vcc, s6, v74
    s_cbranch_vccnz RC_38
RC_39:
    v_mfma_f32_16x16x16_bf16 v[84:87], v[56:57], v[72:73], 0
    s_nop 7
    v_add_f32_dpp v84, v85, v84 row_shl:4 row_mask:0xf bank_mask:0xf
    v_mul_f32 v84, v84, v60
    v_cvt_pk_bf16_f32 v84, v84, v84
    s_nop 1
    v_mov_b32_dpp v84, v84 row_shr:4 row_mask:0xf bank_mask:0xa
    s_nop 1
    v_and_b32_dpp v10, v84, v4 quad_perm:[0,0,0,0] row_mask:0xf bank_mask:0xf
    v_and_b32_dpp v11, v84, v5 quad_perm:[0,0,0,0] row_mask:0xf bank_mask:0xf
    v_and_b32_dpp v12, v84, v6 quad_perm:[0,0,0,0] row_mask:0xf bank_mask:0xf
    v_and_b32_dpp v13, v84, v7 quad_perm:[0,0,0,0] row_mask:0xf bank_mask:0xf
    v_and_b32_dpp v14, v84, v4 quad_perm:[1,1,1,1] row_mask:0xf bank_mask:0xf
    v_and_b32_dpp v15, v84, v5 quad_perm:[1,1,1,1] row_mask:0xf bank_mask:0xf
    v_and_b32_dpp v16, v84, v6 quad_perm:[1,1,1,1] row_mask:0xf bank_mask:0xf
    v_and_b32_dpp v17, v84, v7 quad_perm:[1,1,1,1] row_mask:0xf bank_mask:0xf
    v_mfma_f32_16x16x32_bf16 v[88:91], v[10:13], v[208:211], 0
    v_mfma_f32_16x16x32_bf16 v[92:95], v[10:13], v[224:227], 0
    v_and_b32_dpp v10, v84, v4 quad_perm:[2,2,2,2] row_mask:0xf bank_mask:0xf
    v_and_b32_dpp v11, v84, v5 quad_perm:[2,2,2,2] row_mask:0xf bank_mask:0xf
    v_and_b32_dpp v12, v84, v6 quad_perm:[2,2,2,2] row_mask:0xf bank_mask:0xf
    v_and_b32_dpp v13, v84, v7 quad_perm:[2,2,2,2] row_mask:0xf bank_mask:0xf
    v_mfma_f32_16x16x32_bf16 v[88:91], v[14:17], v[212:215], v[88:91]
    v_mfma_f32_16x16x32_bf16 v[92:95], v[14:17], v[228:231], v[92:95]
    v_and_b32_dpp v14, v84, v4 quad_perm:[3,3,3,3] row_mask:0xf bank_mask:0xf
    v_and_b32_dpp v15, v84, v5 quad_perm:[3,3,3,3] row_mask:0xf bank_mask:0xf
    v_and_b32_dpp v16, v84, v6 quad_perm:[3,3,3,3] row_mask:0xf bank_mask:0xf
    v_and_b32_dpp v17, v84, v7 quad_perm:[3,3,3,3] row_mask:0xf bank_mask:0xf
    v_mfma_f32_16x16x32_bf16 v[88:91], v[10:13], v[216:219], v[88:91]
    v_mfma_f32_16x16x32_bf16 v[92:95], v[10:13], v[232:235], v[92:95]
    v_mfma_f32_16x16x32_bf16 v[88:91], v[14:17], v[220:223], v[88:91]
    v_mfma_f32_16x16x32_bf16 v[92:95], v[14:17], v[236:239], v[92:95]
    s_nop 7
    v_permlane32_swap_b32 v92, v90
    v_permlane32_swap_b32 v93, v91
    s_nop 0
    v_add_f32_dpp v86, v88, v90 quad_perm:[0,1,2,3] row_mask:0x3 bank_mask:0xf
    v_add_f32_dpp v87, v89, v91 quad_perm:[0,1,2,3] row_mask:0x3 bank_mask:0xf
    s_nop 0
    v_add_f32_dpp v86, v92, v94 quad_perm:[0,1,2,3] row_mask:0xc bank_mask:0xf
    v_add_f32_dpp v87, v93, v95 quad_perm:[0,1,2,3] row_mask:0xc bank_mask:0xf
    ds_write_b64 v26, v[86:87] offset:12288
    s_mov_b32 s90, 4
    s_lshl_b32 s8, s5, 3
    s_add_u32 s8, s8, s4
    s_waitcnt lgkmcnt(0)
    s_barrier
    s_cmp_lt_u32 s8, 8
    s_cbranch_scc1 L_XDN
    s_cmp_lg_u32 s5, 3
    s_cbranch_scc1 L_XFIN
    ds_read_b128 v[136:139], v24 offset:12288
    ds_read_b128 v[140:143], v24 offset:13344
    s_waitcnt lgkmcnt(0)
    v_add_f32 v136, v136, v140
    v_add_f32 v137, v137, v141
    v_add_f32 v138, v138, v142
    v_add_f32 v139, v139, v143
    v_add_f32_dpp v136, v136, v136 quad_perm:[1,0,3,2] row_mask:0xf bank_mask:0xf
    v_add_f32_dpp v137, v137, v137 quad_perm:[1,0,3,2] row_mask:0xf bank_mask:0xf
    v_add_f32_dpp v138, v138, v138 quad_perm:[1,0,3,2] row_mask:0xf bank_mask:0xf
    v_add_f32_dpp v139, v139, v139 quad_perm:[1,0,3,2] row_mask:0xf bank_mask:0xf
    v_cvt_pk_bf16_f32 v104, v136, v137
    v_cvt_pk_bf16_f32 v105, v138, v139
    s_cmp_eq_u32 s98, 0
    s_cbranch_scc1 SL_40
    s_mov_b32 exec_lo, 0x55555555
    s_mov_b32 exec_hi, 0x55555555
    buffer_store_dwordx4 v[104:107], v25, s[44:47], s12 offen
SL_41:
    s_mov_b64 exec, -1
L_XFIN:
    s_endpgm
RC_36:
    s_mov_b32 s7, 20000
    s_branch AW_44
AL_42:
    buffer_load_dwordx3 v[76:78], v22, s[44:47], s10 offen sc1
    s_waitcnt vmcnt(0)
    v_cmp_ne_u32 vcc, s6, v78
AW_44:
    s_cmp_eq_u64 exec, -1
    s_cselect_b64 s[94:95], -1, 0
    s_andn2_b64 s[94:95], s[94:95], vcc
    s_cmp_eq_u64 s[94:95], -1
    s_cbranch_scc1 AD_43
    s_ff1_i32_b64 s94, vcc
    s_lshl_b64 s[94:95], 1, s94
    s_cmp_eq_u64 vcc, 0
    s_cselect_b64 exec, -1, s[94:95]
    s_sub_u32 s7, s7, 1
    s_cbranch_scc0 AL_42
    s_mov_b64 exec, -1
    s_branch AD_43
PAD_10:
    s_branch L_WRET
AD_43:
    s_branch RC_37
PAD_11:
    s_branch L_WRET
RC_38:
    s_mov_b32 s7, 20000
FL_45:
    s_mov_b64 exec, vcc
    buffer_load_dwordx3 v[72:74], v23, s[44:47], s11 offen sc1
    s_waitcnt vmcnt(0)
    v_cmp_ne_u32 vcc, s6, v74
    s_cbranch_vccz FD_46
    s_sub_u32 s7, s7, 1
    s_cbranch_scc0 FL_45
FD_46:
    s_mov_b64 exec, -1
    s_branch RC_39
PAD_12:
    s_branch L_WRET
PAD_13:
    s_branch L_WRET
L_Y:
    s_mov_b32 s4, s8
    s_lshr_b32 s8, s8, 2
    s_lshl_b32 s64, s3, 2
    s_add_u32 s64, s64, s8
    s_and_b32 s65, s4, 3
    s_lshl_b32 s66, s64, 8
    s_mov_b32 s48, s20
    s_mov_b32 s49, s21
    s_mov_b32 s50, 0x480000
    s_mov_b32 s51, 0x00020000
    s_mov_b32 s60, s16
    s_mov_b32 s61, s17
    s_mov_b32 s62, 0x480
    s_mov_b32 s63, 0x00020000
    s_cmp_ge_u32 s5, 6
    s_cbranch_scc1 L_YK0
    v_lshlrev_b32 v28, 13, v3
    v_lshl_add_u32 v28, v2, 4, v28
    s_mul_i32 s67, s65, 144
    s_mul_i32 s8, s5, 24
    s_add_u32 s67, s67, s8
    s_lshl_b32 s9, s67, 13
    s_add_u32 s9, s9, s66
    v_lshlrev_b32 v20, 4, v1
    buffer_load_dwordx4 v[72:75], v20, s[60:63], 0 offen
    buffer_load_dwordx4 v[76:79], v20, s[60:63], 0 offen offset:1024
    buffer_load_dwordx4 v[32:35], v28, s[48:51], s9 offen nt
    s_add_u32 s9, s9, 0x8000
    buffer_load_dwordx4 v[36:39], v28, s[48:51], s9 offen nt
    s_add_u32 s9, s9, 0x8000
    buffer_load_dwordx4 v[40:43], v28, s[48:51], s9 offen nt
    s_add_u32 s9, s9, 0x8000
    buffer_load_dwordx4 v[44:47], v28, s[48:51], s9 offen nt
    s_add_u32 s9, s9, 0x8000
    buffer_load_dwordx4 v[48:51], v28, s[48:51], s9 offen nt
    s_add_u32 s9, s9, 0x8000
    buffer_load_dwordx4 v[52:55], v28, s[48:51], s9 offen nt
    v_and_b32 v21, 7, v2
    v_min_u32 v21, 5, v21
    v_lshl_add_u32 v22, v21, 2, v3
    v_lshlrev_b32 v22, 1, v22
    s_lshl_b32 s10, s67, 1
    buffer_load_ushort v80, v22, s[60:63], s10 offen
    s_mov_b32 s52, s22
    s_mov_b32 s53, s23
    s_mov_b32 s54, 0x400000
    s_mov_b32 s55, 0x00020000
    v_and_b32 v26, 3, v2
    v_lshlrev_b32 v26, 4, v26
    v_lshl_add_u32 v26, v3, 6, v26
    v_lshrrev_b32 v27, 2, v2
    v_lshl_add_u32 v29, v27, 15, v26
    v_lshl_add_u32 v26, v27, 9, v26
    s_and_b32 s12, s5, 1
    s_lshl_b32 s8, s4, 1
    s_add_u32 s12, s12, s8
    s_lshr_b32 s8, s5, 1
    s_lshl_b32 s69, s3, 2
    s_add_u32 s69, s69, s8
    s_lshl_b32 s11, s12, 17
    s_lshl_b32 s8, s69, 8
    s_add_u32 s11, s11, s8
    s_lshl_b32 s68, s69, 11
    s_add_u32 s68, s68, 196608
    buffer_load_dwordx4 v[56:59], v29, s[52:55], s11 offen nt
    s_add_u32 s11, s11, 0x2000
    buffer_load_dwordx4 v[60:63], v29, s[52:55], s11 offen nt
    s_add_u32 s11, s11, 0x2000
    buffer_load_dwordx4 v[64:67], v29, s[52:55], s11 offen nt
    s_add_u32 s11, s11, 0x2000
    buffer_load_dwordx4 v[68:71], v29, s[52:55], s11 offen nt
    s_waitcnt lgkmcnt(0)
    s_or_b32 s6, s99, 0x40004000
    s_add_u32 s6, s6, 1
    s_and_b32 s6, s6, 0xbfffbfff
    s_waitcnt vmcnt(11)
    v_mov_b32 v81, 0x3f803f80
    v_mov_b32 v82, 0
    v_mov_b32 v83, 0
    v_dot2_f32_bf16 v82, v72, v81, v82
    v_dot2_f32_bf16 v83, v72, v72, v83
    v_dot2_f32_bf16 v82, v73, v81, v82
    v_dot2_f32_bf16 v83, v73, v73, v83
    v_dot2_f32_bf16 v82, v74, v81, v82
    v_dot2_f32_bf16 v83, v74, v74, v83
    v_dot2_f32_bf16 v82, v75, v81, v82
    v_dot2_f32_bf16 v83, v75, v75, v83
    v_dot2_f32_bf16 v82, v76, v81, v82
    v_dot2_f32_bf16 v83, v76, v76, v83
    v_dot2_f32_bf16 v82, v77, v81, v82
    v_dot2_f32_bf16 v83, v77, v77, v83
    v_dot2_f32_bf16 v82, v78, v81, v82
    v_dot2_f32_bf16 v83, v78, v78, v83
    v_dot2_f32_bf16 v82, v79, v81, v82
    v_dot2_f32_bf16 v83, v79, v79, v83
    s_nop 1
    v_add_f32_dpp v82, v82, v82 row_ror:8 row_mask:0xf bank_mask:0xf
    v_add_f32_dpp v83, v83, v83 row_ror:8 row_mask:0xf bank_mask:0xf
    s_nop 0
    v_add_f32_dpp v82, v82, v82 row_ror:4 row_mask:0xf bank_mask:0xf
    v_add_f32_dpp v83, v83, v83 row_ror:4 row_mask:0xf bank_mask:0xf
    s_nop 0
    v_add_f32_dpp v82, v82, v82 row_ror:2 row_mask:0xf bank_mask:0xf
    v_add_f32_dpp v83, v83, v83 row_ror:2 row_mask:0xf bank_mask:0xf
    s_nop 0
    v_add_f32_dpp v82, v82, v82 row_ror:1 row_mask:0xf bank_mask:0xf
    v_add_f32_dpp v83, v83, v83 row_ror:1 row_mask:0xf bank_mask:0xf
    v_mov_b32 v84, v82
    s_nop 1
    v_permlane16_swap_b32 v82, v84
    v_add_f32 v82, v82, v84
    v_mov_b32 v84, v82
    s_nop 1
    v_permlane32_swap_b32 v82, v84
    v_add_f32 v82, v82, v84
    v_mov_b32 v84, v83
    s_nop 1
    v_permlane16_swap_b32 v83, v84
    v_add_f32 v83, v83, v84
    v_mov_b32 v84, v83
    s_nop 1
    v_permlane32_swap_b32 v83, v84
    v_add_f32 v83, v83, v84
    v_mul_f32 v82, 0x3ae38e39, v82
    v_mul_f32 v83, 0x3ae38e39, v83
    v_fma_f32 v83, -v82, v82, v83
    v_max_f32 v83, 0, v83
    v_add_f32 v83, 0x3727c5ac, v83
    v_rsq_f32 v83, v83
    v_lshrrev_b32 v22, 3, v2
    v_mul_u32_u24 v22, 144, v22
    v_add_u32 v22, v22, v21
    v_lshlrev_b32 v22, 4, v22
    v_mul_u32_u24 v23, 13824, v3
    v_add_u32 v22, v22, v23
    v_mul_f32 v83, 0x3e0293ee, v83
    s_lshl_b32 s8, s67, 2
    s_add_u32 s10, s8, 65536
    s_add_u32 s13, s10, 55296
    s_waitcnt vmcnt(5)
    buffer_load_dwordx3 v[72:74], v22, s[44:47], s10 offen sc1
    buffer_load_dwordx3 v[76:78], v22, s[44:47], s13 offen sc1
    s_mul_i32 s8, s5, 528
    v_lshlrev_b32 v23, 5, v2
    v_lshl_add_u32 v23, v3, 4, v23
    v_add_u32 v23, s8, v23
    v_mov_b32 v132, s6
    v_mov_b32 v133, s6
    s_lshl_b32 s12, s12, 11
    s_lshl_b32 s8, s69, 6
    s_add_u32 s12, s12, s8
    s_add_u32 s12, s12, 262144
    v_lshlrev_b32 v27, 4, v3
    s_waitcnt vmcnt(6)
    v_lshlrev_b32 v80, 16, v80
    v_sub_f32 v80, v80, v82
    v_mul_f32 v80, v80, v83
    v_mov_b32 v81, 0x3e0293ee
    v_cmp_gt_u32 vcc, 8, v2
    s_nop 1
    v_cndmask_b32 v81, v80, v81, vcc
    v_cndmask_b32 v80, v80, 0, vcc
    s_waitcnt vmcnt(0)
    v_bitop3_b32 v84, v74, v78, s6 bitop3:0x7e
    v_cmp_ne_u32 vcc, 0, v84
    s_cbranch_vccnz RC_47
RC_48:
    v_mfma_f32_16x16x16_bf16 v[84:87], v[8:9], v[72:73], 0
    v_mfma_f32_16x16x16_bf16 v[84:87], v[8:9], v[76:77], v[84:87]
    s_nop 7
    v_fma_f32 v84, v84, v81, v80
    s_nop 1
    v_add_f32_dpp v84, v84, v84 row_ror:8 row_mask:0xf bank_mask:0xf
    v_cvt_pk_bf16_f32 v84, v84, v84
    s_nop 1
    v_and_b32_dpp v10, v84, v4 row_newbcast:0 row_mask:0xf bank_mask:0xf
    v_and_b32_dpp v11, v84, v5 row_newbcast:0 row_mask:0xf bank_mask:0xf
    v_and_b32_dpp v12, v84, v6 row_newbcast:0 row_mask:0xf bank_mask:0xf
    v_and_b32_dpp v13, v84, v7 row_newbcast:0 row_mask:0xf bank_mask:0xf
    v_and_b32_dpp v14, v84, v4 row_newbcast:1 row_mask:0xf bank_mask:0xf
    v_and_b32_dpp v15, v84, v5 row_newbcast:1 row_mask:0xf bank_mask:0xf
    v_and_b32_dpp v16, v84, v6 row_newbcast:1 row_mask:0xf bank_mask:0xf
    v_and_b32_dpp v17, v84, v7 row_newbcast:1 row_mask:0xf bank_mask:0xf
    v_mfma_f32_16x16x32_bf16 v[88:91], v[10:13], v[32:35], 0
    v_and_b32_dpp v10, v84, v4 row_newbcast:2 row_mask:0xf bank_mask:0xf
    v_and_b32_dpp v11, v84, v5 row_newbcast:2 row_mask:0xf bank_mask:0xf
    v_and_b32_dpp v12, v84, v6 row_newbcast:2 row_mask:0xf bank_mask:0xf
    v_and_b32_dpp v13, v84, v7 row_newbcast:2 row_mask:0xf bank_mask:0xf
    v_mfma_f32_16x16x32_bf16 v[88:91], v[14:17], v[36:39], v[88:91]
    v_and_b32_dpp v14, v84, v4 row_newbcast:3 row_mask:0xf bank_mask:0xf
    v_and_b32_dpp v15, v84, v5 row_newbcast:3 row_mask:0xf bank_mask:0xf
    v_and_b32_dpp v16, v84, v6 row_newbcast:3 row_mask:0xf bank_mask:0xf
    v_and_b32_dpp v17, v84, v7 row_newbcast:3 row_mask:0xf bank_mask:0xf
    v_mfma_f32_16x16x32_bf16 v[88:91], v[10:13], v[40:43], v[88:91]
    v_and_b32_dpp v10, v84, v4 row_newbcast:4 row_mask:0xf bank_mask:0xf
    v_and_b32_dpp v11, v84, v5 row_newbcast:4 row_mask:0xf bank_mask:0xf
    v_and_b32_dpp v12, v84, v6 row_newbcast:4 row_mask:0xf bank_mask:0xf
    v_and_b32_dpp v13, v84, v7 row_newbcast:4 row_mask:0xf bank_mask:0xf
    v_mfma_f32_16x16x32_bf16 v[88:91], v[14:17], v[44:47], v[88:91]
    v_and_b32_dpp v14, v84, v4 row_newbcast:5 row_mask:0xf bank_mask:0xf
    v_and_b32_dpp v15, v84, v5 row_newbcast:5 row_mask:0xf bank_mask:0xf
    v_and_b32_dpp v16, v84, v6 row_newbcast:5 row_mask:0xf bank_mask:0xf
    v_and_b32_dpp v17, v84, v7 row_newbcast:5 row_mask:0xf bank_mask:0xf
    v_mfma_f32_16x16x32_bf16 v[88:91], v[10:13], v[48:51], v[88:91]
    s_nop 0
    v_mfma_f32_16x16x32_bf16 v[88:91], v[14:17], v[52:55], v[88:91]
    s_mov_b32 exec_lo, 0xffffffff
    s_mov_b32 exec_hi, 0x0
    s_nop 5
    ds_write_b128 v23, v[88:91] offset:0
    s_mov_b64 exec, -1
    s_waitcnt lgkmcnt(0)
    s_barrier
    s_branch L_YK1
RC_47:
    s_mov_b32 s7, 20000
FL_49:
    s_mov_b64 exec, vcc
    buffer_load_dwordx3 v[72:74], v22, s[44:47], s10 offen sc1
    buffer_load_dwordx3 v[76:78], v22, s[44:47], s13 offen sc1
    s_waitcnt vmcnt(0)
    v_bitop3_b32 v84, v74, v78, s6 bitop3:0x7e
    v_cmp_ne_u32 vcc, 0, v84
    s_cbranch_vccz FD_50
    s_sub_u32 s7, s7, 1
    s_cbranch_scc0 FL_49
FD_50:
    s_mov_b64 exec, -1
    s_branch RC_48
PAD_14:
    s_branch PAD_25
PAD_15:
    s_branch L_WRET
L_YK0:
    s_mov_b32 s52, s22
    s_mov_b32 s53, s23
    s_mov_b32 s54, 0x400000
    s_mov_b32 s55, 0x00020000
    v_and_b32 v26, 3, v2
    v_lshlrev_b32 v26, 4, v26
    v_lshl_add_u32 v26, v3, 6, v26
    v_lshrrev_b32 v27, 2, v2
    v_lshl_add_u32 v29, v27, 15, v26
    v_lshl_add_u32 v26, v27, 9, v26
    s_and_b32 s12, s5, 1
    s_lshl_b32 s8, s4, 1
    s_add_u32 s12, s12, s8
    s_lshr_b32 s8, s5, 1
    s_lshl_b32 s69, s3, 2
    s_add_u32 s69, s69, s8
    s_lshl_b32 s11, s12, 17
    s_lshl_b32 s8, s69, 8
    s_add_u32 s11, s11, s8
    s_lshl_b32 s68, s69, 11
    s_add_u32 s68, s68, 196608
    s_setprio 3
    s_lshl_b32 s70, s64, 11
    s_add_u32 s70, s70, 196608
    s_waitcnt lgkmcnt(0)
    s_or_b32 s6, s99, 0x40004000
    s_add_u32 s6, s6, 1
    s_and_b32 s6, s6, 0xbfffbfff
    s_cmp_eq_u32 s5, 7
    s_cbranch_scc1 L_YD7
    s_getreg_b32 s9, hwreg(HW_REG_XCC_ID, 0, 4)
    s_lshl_b32 s8, s3, 8
    s_and_b32 s10, s2, 0xf8
    s_add_u32 s8, s8, s10
    s_add_u32 s8, s8, 4096
    v_mov_b32 v72, s9
    v_mov_b32 v73, s6
    v_mov_b32 v74, 0
    s_mov_b32 exec_lo, 0x1
    s_mov_b32 exec_hi, 0x0
    buffer_store_dwordx2 v[72:73], v74, s[44:47], s8 offen
    s_mov_b64 exec, -1
    buffer_load_dwordx4 v[72:75], v26, s[44:47], s70 offen sc1
    buffer_load_dwordx4 v[76:79], v26, s[44:47], s70 offen offset:256 sc1
L_YD7:
    s_setprio 0
    buffer_load_dwordx4 v[56:59], v29, s[52:55], s11 offen nt
    s_add_u32 s11, s11, 0x2000
    buffer_load_dwordx4 v[60:63], v29, s[52:55], s11 offen nt
    s_add_u32 s11, s11, 0x2000
    buffer_load_dwordx4 v[64:67], v29, s[52:55], s11 offen nt
    s_add_u32 s11, s11, 0x2000
    buffer_load_dwordx4 v[68:71], v29, s[52:55], s11 offen nt
    v_and_b32 v20, 31, v1
    v_lshlrev_b32 v20, 3, v20
    s_lshl_b32 s13, s3, 8
    s_add_u32 s13, s13, 4096
    v_and_b32 v24, 1, v1
    v_mul_u32_u24 v24, 528, v24
    v_bfe_u32 v25, v1, 1, 4
    v_lshl_add_u32 v24, v25, 5, v24
    v_lshrrev_b32 v27, 5, v1
    v_lshl_add_u32 v24, v27, 4, v24
    v_lshlrev_b32 v25, 4, v25
    v_lshl_add_u32 v25, v27, 8, v25
    v_mov_b32 v128, s6
    v_mov_b32 v129, s6
    s_lshl_b32 s8, s65, 9
    s_add_u32 s14, s70, s8
    s_lshl_b32 s8, s3, 5
    s_add_u32 s8, s8, s4
    s_lshl_b32 s15, s8, 2
    s_add_u32 s15, s15, 8192
    s_waitcnt vmcnt(0)
    v_mov_b32 v132, s6
    v_mov_b32 v133, s6
    s_lshl_b32 s12, s12, 11
    s_lshl_b32 s8, s69, 6
    s_add_u32 s12, s12, s8
    s_add_u32 s12, s12, 262144
    v_lshlrev_b32 v27, 4, v3
    s_cmp_lg_u32 s5, 7
    s_cbranch_scc1 L_YQB
    s_mov_b32 s7, 12
L_YDL:
    buffer_load_dwordx2 v[80:81], v20, s[44:47], s13 offen sc1
    s_waitcnt vmcnt(0)
    s_getreg_b32 s9, hwreg(HW_REG_XCC_ID, 0, 4)
    v_xor_b32 v80, s9, v80
    v_xor_b32 v81, s6, v81
    v_or_b32 v80, v80, v81
    v_cmp_ne_u32 vcc, 0, v80
    s_cmp_eq_u64 vcc, 0
    s_cselect_b32 s98, 1, 0
    s_cbranch_scc1 L_YQB
    s_sub_u32 s7, s7, 1
    s_cbranch_scc0 L_YDL
L_YQB:
    s_barrier
    s_cmp_lg_u32 s5, 7
    s_cbranch_scc1 L_YK1
    ds_read_b128 v[136:139], v24 offset:0
    ds_read_b128 v[140:143], v24 offset:1056
    ds_read_b128 v[144:147], v24 offset:2112
    s_waitcnt lgkmcnt(1)
    v_add_f32 v136, v136, v140
    v_add_f32 v137, v137, v141
    v_add_f32 v138, v138, v142
    v_add_f32 v139, v139, v143
    s_waitcnt lgkmcnt(0)
    v_add_f32 v136, v136, v144
    v_add_f32 v137, v137, v145
    v_add_f32 v138, v138, v146
    v_add_f32 v139, v139, v147
    v_add_f32_dpp v136, v136, v136 quad_perm:[1,0,3,2] row_mask:0xf bank_mask:0xf
    v_add_f32_dpp v137, v137, v137 quad_perm:[1,0,3,2] row_mask:0xf bank_mask:0xf
    v_add_f32_dpp v138, v138, v138 quad_perm:[1,0,3,2] row_mask:0xf bank_mask:0xf
    v_add_f32_dpp v139, v139, v139 quad_perm:[1,0,3,2] row_mask:0xf bank_mask:0xf
    v_cvt_pk_bf16_f32 v130, v136, v137
    v_cvt_pk_bf16_f32 v131, v138, v139
    s_cmp_eq_u32 s98, 0
    s_cbranch_scc1 SL_51
    s_mov_b32 exec_lo, 0x55555555
    s_mov_b32 exec_hi, 0x0
    buffer_store_dwordx4 v[128:131], v25, s[44:47], s14 offen
    s_mov_b32 exec_lo, 0x0
    s_mov_b32 exec_hi, 0x55555555
    buffer_store_dwordx4 v[130:133], v25, s[44:47], s14 offen
SL_52:
    s_mov_b64 exec, -1
L_YK1:
    s_mov_b32 s7, 20000
PL_53:
    buffer_load_dwordx4 v[72:75], v26, s[44:47], s68 offen sc1
    buffer_load_dwordx4 v[76:79], v26, s[44:47], s68 offen offset:256 sc1
    s_waitcnt vmcnt(0)
    v_bitop3_b32 v80, v73, v79, s6 bitop3:0x7e
    v_cmp_ne_u32 vcc, 0, v80
    s_cbranch_vccz PD_54
    s_sub_u32 s7, s7, 1
    s_cbranch_scc0 PL_53
    s_branch PD_54
PAD_16:
    s_branch L_WRET
PD_54:
    v_mfma_f32_16x16x32_bf16 v[80:83], v[56:59], v[74:77], 0
    v_mfma_f32_16x16x32_bf16 v[84:87], v[60:63], v[74:77], 0
    v_mfma_f32_16x16x32_bf16 v[88:91], v[64:67], v[74:77], 0
    v_mfma_f32_16x16x32_bf16 v[92:95], v[68:71], v[74:77], 0
    s_nop 4
    v_add_f32_dpp v80, v81, v80 quad_perm:[1,1,1,1] row_mask:0xf bank_mask:0xf
    v_add_f32_dpp v82, v83, v82 quad_perm:[3,3,3,3] row_mask:0xf bank_mask:0xf
    v_add_f32_dpp v84, v85, v84 quad_perm:[1,1,1,1] row_mask:0xf bank_mask:0xf
    v_add_f32_dpp v86, v87, v86 quad_perm:[3,3,3,3] row_mask:0xf bank_mask:0xf
    v_add_f32_dpp v88, v89, v88 quad_perm:[1,1,1,1] row_mask:0xf bank_mask:0xf
    v_add_f32_dpp v90, v91, v90 quad_perm:[3,3,3,3] row_mask:0xf bank_mask:0xf
    v_add_f32_dpp v92, v93, v92 quad_perm:[1,1,1,1] row_mask:0xf bank_mask:0xf
    v_add_f32_dpp v94, v95, v94 quad_perm:[3,3,3,3] row_mask:0xf bank_mask:0xf
    v_add_f32_dpp v80, v82, v80 quad_perm:[2,2,2,2] row_mask:0xf bank_mask:0xf
    v_add_f32_dpp v84, v86, v84 quad_perm:[2,2,2,2] row_mask:0xf bank_mask:0xf
    v_add_f32_dpp v88, v90, v88 quad_perm:[2,2,2,2] row_mask:0xf bank_mask:0xf
    v_add_f32_dpp v92, v94, v92 quad_perm:[2,2,2,2] row_mask:0xf bank_mask:0xf
    v_add_f32_dpp v80, v80, v80 row_ror:4 row_mask:0xf bank_mask:0xf
    v_add_f32_dpp v84, v84, v84 row_ror:4 row_mask:0xf bank_mask:0xf
    v_add_f32_dpp v88, v88, v88 row_ror:4 row_mask:0xf bank_mask:0xf
    v_add_f32_dpp v92, v92, v92 row_ror:4 row_mask:0xf bank_mask:0xf
    v_add_f32_dpp v80, v80, v80 row_ror:8 row_mask:0xf bank_mask:0xf
    v_add_f32_dpp v84, v84, v84 row_ror:8 row_mask:0xf bank_mask:0xf
    v_add_f32_dpp v88, v88, v88 row_ror:8 row_mask:0xf bank_mask:0xf
    v_add_f32_dpp v92, v92, v92 row_ror:8 row_mask:0xf bank_mask:0xf
    v_cvt_pk_bf16_f32 v130, v80, v84
    v_cvt_pk_bf16_f32 v131, v88, v92
    s_mov_b32 exec_lo, 0x10001
    s_mov_b32 exec_hi, 0x10001
    buffer_store_dwordx4 v[130:133], v27, s[44:47], s12 offen sc1
    s_mov_b64 exec, -1
    s_cmp_lg_u32 s5, 7
    s_cbranch_scc1 L_YH2
    s_lshl_b32 s8, s3, 5
    s_add_u32 s8, s8, s4
    s_lshl_b32 s15, s8, 2
    s_add_u32 s15, s15, 8192
    s_cmp_eq_u32 s98, 0
    s_cbranch_scc1 SL_55
    s_mov_b32 exec_lo, 0x1
    s_mov_b32 exec_hi, 0x0
    buffer_store_dword v132, v27, s[44:47], s15 offen
SL_56:
    s_mov_b64 exec, -1
L_YH2:
    s_barrier
    s_cmp_lg_u32 s5, 6
    s_cbranch_scc1 L_YKD
    s_cmp_ge_u32 s4, 14
    s_cbranch_scc1 L_YKD
    s_lshr_b32 s9, s30, 7
    s_add_u32 s9, s9, s3
    s_add_u32 s9, s9, s4
    s_and_b32 s9, s9, 7
    s_cmp_ge_u32 s4, 9
    s_cselect_b32 s9, 0, s9
    s_cmp_eq_u32 s9, 3
    s_cbranch_scc1 L_YKD
    s_lshl_b32 s8, s3, 7
    s_add_u32 s8, s8, 9216
    v_lshlrev_b32 v20, 2, v2
    s_mov_b32 exec_lo, 0xffff
    s_mov_b32 exec_hi, 0x0
    s_mov_b32 s7, 20000
PL_57:
    buffer_load_dword v21, v20, s[44:47], s8 offen sc1
    s_waitcnt vmcnt(0)
    v_cmp_ne_u32 vcc, s6, v21
    s_cbranch_vccz PD_58
    s_sub_u32 s7, s7, 1
    s_cbranch_scc0 PL_57
    s_branch PD_58
PAD_17:
    s_branch L_WRET
PD_58:
    s_mov_b64 exec, -1
L_YKD:
    s_barrier
    s_lshl_b32 s8, s3, 4
    s_add_u32 s8, s8, s4
    s_lshl_b32 s8, s8, 3
    s_add_u32 s8, s8, s5
    s_lshl_b32 s8, s8, 12
    s_add_u32 s8, s8, 2097152
    v_lshlrev_b32 v20, 6, v1
    v_lshlrev_b32 v20, 1, v20
    s_mov_b32 exec_lo, 0xffffffff
    s_mov_b32 exec_hi, 0x0
    buffer_load_dword v250, v20, s[44:47], s8 offen sc1
    s_mov_b64 exec, -1
    s_cmp_ge_u32 s4, 9
    s_cbranch_scc1 L_YO
    s_mov_b32 s48, s30
    s_mov_b32 s49, s31
    s_mov_b32 s50, 0x510000
    s_mov_b32 s51, 0x00020000
    s_mov_b32 s52, s32
    s_mov_b32 s53, s33
    s_mov_b32 s54, 0x510000
    s_mov_b32 s55, 0x00020000
    v_lshrrev_b32 v30, 3, v2
    v_mul_u32_u24 v30, 32, v30
    v_add_u32 v30, v30, v3
    v_mul_u32_u24 v28, 9216, v30
    v_and_b32 v30, 7, v2
    v_lshl_add_u32 v28, v30, 4, v28
    v_lshrrev_b32 v30, 3, v2
    v_mul_u32_u24 v30, 4, v30
    v_add_u32 v30, v30, v3
    v_mul_u32_u24 v29, 9216, v30
    v_and_b32 v30, 7, v2
    v_lshl_add_u32 v29, v30, 4, v29
    s_mul_i32 s66, s3, 9
    s_add_u32 s66, s66, s4
    s_mul_i32 s82, s5, 663552
    s_lshl_b32 s9, s66, 7
    s_add_u32 s82, s82, s9
    s_add_u32 s83, s82, 589824
    s_cmp_ge_u32 s4, 9
    s_cselect_b32 s67, -9, 0
    s_lshl_b32 s9, s67, 7
    s_add_u32 s68, s82, s9
    s_add_u32 s69, s83, s9
    s_add_u32 s67, s67, s66
    buffer_load_dwordx4 v[64:67], v29, s[48:51], s83 offen nt
    buffer_load_dwordx4 v[100:103], v29, s[52:55], s69 offen nt
    v_lshl_add_u32 v21, v2, 2, v3
    v_lshlrev_b32 v21, 1, v21
    v_lshrrev_b32 v23, 3, v2
    v_lshl_add_u32 v23, v23, 2, v3
    v_lshlrev_b32 v23, 1, v23
    s_movk_i32 s84, 2304
    s_movk_i32 s85, 13824
    s_mul_i32 s8, s5, 144
    v_lshlrev_b32 v30, 4, v2
    v_mad_u32_u24 v24, v3, s85, v30
    v_mad_u32_u24 v27, v3, s84, v30
    v_bfe_u32 v31, v2, 2, 1
    v_lshl_add_u32 v31, v3, 1, v31
    v_lshrrev_b32 v30, 3, v2
    v_lshlrev_b32 v30, 4, v30
    v_mad_u32_u24 v25, v31, s85, v30
    v_mad_u32_u24 v26, v31, s84, v30
    s_mul_i32 s9, s5, 288
    s_add_u32 s70, s9, 70144
    s_add_u32 s71, s70, 55296
    s_add_u32 s72, s70, 4608
    s_add_u32 s73, s71, 4608
    s_add_u32 s12, s9, 491520
    s_add_u32 s13, s12, 9216
    s_cmp_ge_u32 s5, 4
    s_cselect_b64 vcc, -1, 0
    s_waitcnt vmcnt(1)
    buffer_load_dwordx4 v[32:35], v28, s[48:51], s82 offen nt
    s_add_u32 s82, s82, 36864
    s_waitcnt vmcnt(1)
    buffer_load_dwordx4 v[68:71], v28, s[52:55], s68 offen nt
    s_add_u32 s68, s68, 36864
    s_waitcnt vmcnt(1)
    buffer_load_dwordx4 v[36:39], v28, s[48:51], s82 offen nt
    s_add_u32 s82, s82, 36864
    s_waitcnt vmcnt(1)
    buffer_load_dwordx4 v[72:75], v28, s[52:55], s68 offen nt
    s_add_u32 s68, s68, 36864
    s_waitcnt vmcnt(1)
    buffer_load_dwordx4 v[40:43], v28, s[48:51], s82 offen nt
    s_add_u32 s82, s82, 36864
    s_waitcnt vmcnt(2)
    s_cbranch_vccnz FS_59
    s_waitcnt vmcnt(1)
FS_59:
    buffer_load_dwordx4 v[76:79], v28, s[52:55], s68 offen nt
    s_add_u32 s68, s68, 36864
    s_waitcnt vmcnt(2)
    s_cbranch_vccnz FS_60
    s_waitcnt vmcnt(1)
FS_60:
    buffer_load_dwordx4 v[44:47], v28, s[48:51], s82 offen nt
    s_add_u32 s82, s82, 36864
    s_waitcnt vmcnt(2)
    s_cbranch_vccnz FS_61
    s_waitcnt vmcnt(1)
FS_61:
    buffer_load_dwordx4 v[80:83], v28, s[52:55], s68 offen nt
    s_add_u32 s68, s68, 36864
    s_waitcnt vmcnt(2)
    buffer_load_dwordx4 v[48:51], v28, s[48:51], s82 offen nt
    s_add_u32 s82, s82, 36864
    s_waitcnt vmcnt(2)
    buffer_load_dwordx4 v[84:87], v28, s[52:55], s68 offen nt
    s_add_u32 s68, s68, 36864
    s_waitcnt vmcnt(3)
    s_cbranch_vccnz FS_62
    s_waitcnt vmcnt(2)
FS_62:
    buffer_load_dwordx4 v[52:55], v28, s[48:51], s82 offen nt
    s_add_u32 s82, s82, 36864
    s_waitcnt vmcnt(3)
    s_cbranch_vccnz FS_63
    s_waitcnt vmcnt(2)
FS_63:
    buffer_load_dwordx4 v[88:91], v28, s[52:55], s68 offen nt
    s_add_u32 s68, s68, 36864
    s_waitcnt vmcnt(3)
    s_cbranch_vccnz FS_64
    s_waitcnt vmcnt(2)
FS_64:
    buffer_load_dwordx4 v[56:59], v28, s[48:51], s82 offen nt
    s_add_u32 s82, s82, 36864
    s_waitcnt vmcnt(3)
    buffer_load_dwordx4 v[92:95], v28, s[52:55], s68 offen nt
    s_add_u32 s68, s68, 36864
    s_waitcnt vmcnt(3)
    buffer_load_dwordx4 v[60:63], v28, s[48:51], s82 offen nt
    s_waitcnt vmcnt(3)
    buffer_load_dwordx4 v[96:99], v28, s[52:55], s68 offen nt
    buffer_load_ushort v160, v21, s[60:63], s8 offen
    buffer_load_ushort v161, v23, s[60:63], s8 offen offset:128
    buffer_load_dwordx3 v[104:106], v24, s[44:47], s70 offen sc1
    buffer_load_dwordx3 v[108:110], v24, s[44:47], s71 offen sc1
    buffer_load_dwordx3 v[112:114], v25, s[44:47], s70 offen offset:256 sc1
    buffer_load_dwordx3 v[116:118], v24, s[44:47], s70 offen offset:2304 sc1
    buffer_load_dwordx3 v[120:122], v24, s[44:47], s71 offen offset:2304 sc1
    buffer_load_dwordx3 v[124:126], v25, s[44:47], s70 offen offset:2560 sc1
    buffer_load_dwordx3 v[128:130], v24, s[44:47], s72 offen sc1
    buffer_load_dwordx3 v[132:134], v24, s[44:47], s73 offen sc1
    buffer_load_dwordx3 v[136:138], v25, s[44:47], s72 offen offset:256 sc1
    v_lshlrev_b32 v20, 2, v21
    v_and_b32 v21, 32, v1
    s_lshl_b32 s8, s5, 2
    v_add_u32 v21, s8, v21
    v_and_b32 v30, 1, v3
    v_lshl_add_u32 v30, v2, 1, v30
    v_mul_u32_u24 v22, 144, v30
    v_lshrrev_b32 v30, 1, v3
    v_mul_u32_u24 v30, 2304, v30
    v_add3_u32 v22, v22, v30, s8
    v_mul_u32_u24 v23, 144, v2
    v_lshl_add_u32 v23, v3, 5, v23
    v_mov_b32 v29, 0
    v_mov_b32 v179, s6
    v_mov_b32 v181, s6
    s_lshl_b32 s14, s66, 9
    s_add_u32 s14, s14, 786432
    s_lshl_b32 s15, s67, 10
    s_add_u32 s15, s15, 786432
    s_mul_i32 s8, s3, 2304
    s_add_u32 s9, s12, s8
    s_waitcnt vmcnt(0)
    buffer_load_dwordx3 v[208:210], v27, s[44:47], s12 offen sc1
    buffer_load_dwordx3 v[212:214], v27, s[44:47], s13 offen sc1
    buffer_load_dwordx3 v[216:218], v26, s[44:47], s12 offen offset:256 sc1
    v_bitop3_b32 v30, v106, v110, s6 bitop3:0x7e
    v_bitop3_b32 v30, v30, v114, s6 bitop3:0xf6
    v_bitop3_b32 v30, v30, v118, s6 bitop3:0xf6
    v_bitop3_b32 v30, v30, v122, s6 bitop3:0xf6
    v_bitop3_b32 v30, v30, v126, s6 bitop3:0xf6
    v_bitop3_b32 v30, v30, v130, s6 bitop3:0xf6
    v_bitop3_b32 v30, v30, v134, s6 bitop3:0xf6
    v_bitop3_b32 v30, v30, v138, s6 bitop3:0xf6
    v_cmp_ne_u32 vcc, 0, v30
    s_cbranch_vccnz RC_65
RC_66:
    v_mfma_f32_16x16x16_bf16 v[188:191], v[8:9], v[112:113], 0
    v_mfma_f32_16x16x16_bf16 v[184:187], v[8:9], v[104:105], 0
    v_mfma_f32_16x16x16_bf16 v[184:187], v[8:9], v[108:109], v[184:187]
    v_mfma_f32_16x16x16_bf16 v[196:199], v[8:9], v[124:125], 0
    v_mfma_f32_16x16x16_bf16 v[192:195], v[8:9], v[116:117], 0
    v_mfma_f32_16x16x16_bf16 v[192:195], v[8:9], v[120:121], v[192:195]
    v_mfma_f32_16x16x16_bf16 v[204:207], v[8:9], v[136:137], 0
    v_mfma_f32_16x16x16_bf16 v[200:203], v[8:9], v[128:129], 0
    v_mfma_f32_16x16x16_bf16 v[200:203], v[8:9], v[132:133], v[200:203]
    v_lshlrev_b32 v160, 16, v160
    v_lshlrev_b32 v161, 16, v161
    v_mov_b32_dpp v189, v188 row_shl:4 row_mask:0xf bank_mask:0x5
    s_nop 1
    v_mov_b32_dpp v189, v188 row_shr:4 row_mask:0xf bank_mask:0xa
    v_add_f32 v188, v188, v189
    v_mov_b32_dpp v197, v196 row_shl:4 row_mask:0xf bank_mask:0x5
    s_nop 1
    v_mov_b32_dpp v197, v196 row_shr:4 row_mask:0xf bank_mask:0xa
    v_add_f32 v196, v196, v197
    v_mov_b32_dpp v205, v204 row_shl:4 row_mask:0xf bank_mask:0x5
    s_nop 1
    v_mov_b32_dpp v205, v204 row_shr:4 row_mask:0xf bank_mask:0xa
    v_add_f32 v204, v204, v205
    v_add_f32 v200, 1.0, v200
    v_add_f32 v204, 1.0, v204
    s_waitcnt vmcnt(0)
    v_bitop3_b32 v30, v210, v214, s6 bitop3:0x7e
    v_bitop3_b32 v30, v30, v218, s6 bitop3:0xf6
    v_cmp_ne_u32 vcc, 0, v30
    s_cbranch_vccz L_YEC
    s_mov_b32 exec_lo, 0x1
    s_mov_b32 exec_hi, 0x0
    s_mov_b32 s7, 20000
PL_67:
    buffer_load_dwordx3 v[208:210], v29, s[44:47], s9 offen sc1
    s_waitcnt vmcnt(0)
    v_cmp_ne_u32 vcc, s6, v210
    s_cbranch_vccz PD_68
    s_sub_u32 s7, s7, 1
    s_cbranch_scc0 PL_67
    s_branch PD_68
PAD_18:
    s_branch L_WRET
PD_68:
    s_mov_b64 exec, -1
    s_mov_b32 s7, 20000
PL_69:
    buffer_load_dwordx3 v[208:210], v27, s[44:47], s12 offen sc1
    buffer_load_dwordx3 v[212:214], v27, s[44:47], s13 offen sc1
    buffer_load_dwordx3 v[216:218], v26, s[44:47], s12 offen offset:256 sc1
    s_waitcnt vmcnt(0)
    v_bitop3_b32 v30, v210, v214, s6 bitop3:0x7e
    v_bitop3_b32 v30, v30, v218, s6 bitop3:0xf6
    v_cmp_ne_u32 vcc, 0, v30
    s_cbranch_vccz PD_70
    s_sub_u32 s7, s7, 1
    s_cbranch_scc0 PL_69
    s_branch PD_70
PAD_19:
    s_branch L_WRET
PD_70:
L_YEC:
    v_mfma_f32_16x16x16_bf16 v[152:155], v[8:9], v[216:217], 0
    v_mfma_f32_16x16x16_bf16 v[148:151], v[8:9], v[208:209], 0
    v_mfma_f32_16x16x16_bf16 v[148:151], v[8:9], v[212:213], v[148:151]
    s_nop 5
    v_mov_b32_dpp v153, v152 row_shl:4 row_mask:0xf bank_mask:0x5
    s_nop 1
    v_mov_b32_dpp v153, v152 row_shr:4 row_mask:0xf bank_mask:0xa
    v_fmac_f32 v160, v184, v148
    v_add_f32 v152, v152, v153
    v_fmac_f32 v161, v188, v152
    v_mul_f32 v169, 0x3e000000, v161
    v_add_f32 v168, v160, v169
    v_mul_f32 v169, v169, v161
    v_fmac_f32 v169, v160, v160
    s_nop 1
    v_permlane32_swap_b32 v168, v169
    v_add_f32 v168, v168, v169
    s_nop 1
    v_add_f32_dpp v168, v168, v168 row_ror:8 row_mask:0xf bank_mask:0xf
    s_nop 1
    v_add_f32_dpp v168, v168, v168 row_ror:4 row_mask:0xf bank_mask:0xf
    s_nop 1
    v_add_f32_dpp v168, v168, v168 row_ror:2 row_mask:0xf bank_mask:0xf
    s_nop 1
    v_add_f32_dpp v168, v168, v168 row_ror:1 row_mask:0xf bank_mask:0xf
    v_mov_b32 v169, v168
    s_nop 1
    v_permlane16_swap_b32 v168, v169
    v_add_f32 v168, v168, v169
    ds_write_b32 v21, v168 offset:16384
    s_waitcnt lgkmcnt(0)
    s_barrier
    ds_read_b128 v[136:139], v29 offset:16384
    ds_read_b128 v[140:143], v29 offset:16400
    ds_read_b128 v[144:147], v29 offset:16416
    ds_read_b128 v[148:151], v29 offset:16432
    s_waitcnt lgkmcnt(2)
    v_pk_add_f32 v[136:137], v[136:137], v[138:139]
    v_pk_add_f32 v[140:141], v[140:141], v[142:143]
    v_pk_add_f32 v[136:137], v[136:137], v[140:141]
    v_add_f32 v136, v136, v137
    s_waitcnt lgkmcnt(0)
    v_pk_add_f32 v[144:145], v[144:145], v[146:147]
    v_pk_add_f32 v[148:149], v[148:149], v[150:151]
    v_pk_add_f32 v[144:145], v[144:145], v[148:149]
    v_add_f32 v144, v144, v145
    v_mul_f32 v136, 0x3ae38e39, v136
    v_mul_f32 v144, 0x3ae38e39, v144
    v_fma_f32 v144, -v136, v136, v144
    v_max_f32 v144, 0, v144
    v_add_f32 v144, 0x3727c5ac, v144
    v_rsq_f32 v144, v144
    v_sub_f32 v160, v160, v136
    v_sub_f32 v161, v161, v136
    v_mul_f32 v160, v160, v200
    v_mul_f32 v161, v161, v204
    v_fma_f32 v160, v160, v144, v192
    v_fma_f32 v161, v161, v144, v196
    v_cvt_pk_bf16_f32 v160, v160, v160
    v_cvt_pk_bf16_f32 v161, v161, v161
    s_or_b32 s8, s4, s5
    s_cbranch_scc1 L_WB5
    buffer_wbl2 sc1
L_WB5:
    v_mov_b32 v162, v160
    v_mov_b32 v163, v160
    s_nop 0
    v_mov_b32_dpp v162, v160 row_shr:4 row_mask:0xf bank_mask:0xa
    v_mov_b32_dpp v163, v160 row_shl:4 row_mask:0xf bank_mask:0x5
    v_and_b32 v10, v161, v4
    v_and_b32 v11, v161, v5
    v_and_b32 v12, v161, v6
    v_and_b32 v13, v161, v7
    v_and_b32_dpp v14, v162, v4 quad_perm:[0,0,0,0] row_mask:0xf bank_mask:0xf
    v_and_b32_dpp v15, v162, v5 quad_perm:[0,0,0,0] row_mask:0xf bank_mask:0xf
    v_and_b32_dpp v16, v162, v6 quad_perm:[0,0,0,0] row_mask:0xf bank_mask:0xf
    v_and_b32_dpp v17, v162, v7 quad_perm:[0,0,0,0] row_mask:0xf bank_mask:0xf
    v_mfma_f32_16x16x32_bf16 v[168:171], v[10:13], v[64:67], 0
    v_mfma_f32_16x16x32_bf16 v[172:175], v[10:13], v[100:103], 0
    v_and_b32_dpp v10, v162, v4 quad_perm:[1,1,1,1] row_mask:0xf bank_mask:0xf
    v_and_b32_dpp v11, v162, v5 quad_perm:[1,1,1,1] row_mask:0xf bank_mask:0xf
    v_and_b32_dpp v12, v162, v6 quad_perm:[1,1,1,1] row_mask:0xf bank_mask:0xf
    v_and_b32_dpp v13, v162, v7 quad_perm:[1,1,1,1] row_mask:0xf bank_mask:0xf
    v_mfma_f32_16x16x32_bf16 v[168:171], v[14:17], v[32:35], v[168:171]
    v_mfma_f32_16x16x32_bf16 v[172:175], v[14:17], v[68:71], v[172:175]
    v_and_b32_dpp v14, v162, v4 quad_perm:[2,2,2,2] row_mask:0xf bank_mask:0xf
    v_and_b32_dpp v15, v162, v5 quad_perm:[2,2,2,2] row_mask:0xf bank_mask:0xf
    v_and_b32_dpp v16, v162, v6 quad_perm:[2,2,2,2] row_mask:0xf bank_mask:0xf
    v_and_b32_dpp v17, v162, v7 quad_perm:[2,2,2,2] row_mask:0xf bank_mask:0xf
    v_mfma_f32_16x16x32_bf16 v[168:171], v[10:13], v[36:39], v[168:171]
    v_mfma_f32_16x16x32_bf16 v[172:175], v[10:13], v[72:75], v[172:175]
    v_and_b32_dpp v10, v162, v4 quad_perm:[3,3,3,3] row_mask:0xf bank_mask:0xf
    v_and_b32_dpp v11, v162, v5 quad_perm:[3,3,3,3] row_mask:0xf bank_mask:0xf
    v_and_b32_dpp v12, v162, v6 quad_perm:[3,3,3,3] row_mask:0xf bank_mask:0xf
    v_and_b32_dpp v13, v162, v7 quad_perm:[3,3,3,3] row_mask:0xf bank_mask:0xf
    v_mfma_f32_16x16x32_bf16 v[168:171], v[14:17], v[40:43], v[168:171]
    v_mfma_f32_16x16x32_bf16 v[172:175], v[14:17], v[76:79], v[172:175]
    v_and_b32_dpp v14, v163, v4 quad_perm:[0,0,0,0] row_mask:0xf bank_mask:0xf
    v_and_b32_dpp v15, v163, v5 quad_perm:[0,0,0,0] row_mask:0xf bank_mask:0xf
    v_and_b32_dpp v16, v163, v6 quad_perm:[0,0,0,0] row_mask:0xf bank_mask:0xf
    v_and_b32_dpp v17, v163, v7 quad_perm:[0,0,0,0] row_mask:0xf bank_mask:0xf
    v_mfma_f32_16x16x32_bf16 v[168:171], v[10:13], v[44:47], v[168:171]
    v_mfma_f32_16x16x32_bf16 v[172:175], v[10:13], v[80:83], v[172:175]
    v_and_b32_dpp v10, v163, v4 quad_perm:[1,1,1,1] row_mask:0xf bank_mask:0xf
    v_and_b32_dpp v11, v163, v5 quad_perm:[1,1,1,1] row_mask:0xf bank_mask:0xf
    v_and_b32_dpp v12, v163, v6 quad_perm:[1,1,1,1] row_mask:0xf bank_mask:0xf
    v_and_b32_dpp v13, v163, v7 quad_perm:[1,1,1,1] row_mask:0xf bank_mask:0xf
    v_mfma_f32_16x16x32_bf16 v[168:171], v[14:17], v[48:51], v[168:171]
    v_mfma_f32_16x16x32_bf16 v[172:175], v[14:17], v[84:87], v[172:175]
    v_and_b32_dpp v14, v163, v4 quad_perm:[2,2,2,2] row_mask:0xf bank_mask:0xf
    v_and_b32_dpp v15, v163, v5 quad_perm:[2,2,2,2] row_mask:0xf bank_mask:0xf
    v_and_b32_dpp v16, v163, v6 quad_perm:[2,2,2,2] row_mask:0xf bank_mask:0xf
    v_and_b32_dpp v17, v163, v7 quad_perm:[2,2,2,2] row_mask:0xf bank_mask:0xf
    v_mfma_f32_16x16x32_bf16 v[168:171], v[10:13], v[52:55], v[168:171]
    v_mfma_f32_16x16x32_bf16 v[172:175], v[10:13], v[88:91], v[172:175]
    v_and_b32_dpp v10, v163, v4 quad_perm:[3,3,3,3] row_mask:0xf bank_mask:0xf
    v_and_b32_dpp v11, v163, v5 quad_perm:[3,3,3,3] row_mask:0xf bank_mask:0xf
    v_and_b32_dpp v12, v163, v6 quad_perm:[3,3,3,3] row_mask:0xf bank_mask:0xf
    v_and_b32_dpp v13, v163, v7 quad_perm:[3,3,3,3] row_mask:0xf bank_mask:0xf
    v_mfma_f32_16x16x32_bf16 v[168:171], v[14:17], v[56:59], v[168:171]
    v_mfma_f32_16x16x32_bf16 v[172:175], v[14:17], v[92:95], v[172:175]
    v_mfma_f32_16x16x32_bf16 v[168:171], v[10:13], v[60:63], v[168:171]
    v_mfma_f32_16x16x32_bf16 v[172:175], v[10:13], v[96:99], v[172:175]
    s_nop 7
    v_permlane32_swap_b32 v168, v172
    v_permlane32_swap_b32 v169, v173
    v_permlane32_swap_b32 v170, v174
    v_permlane32_swap_b32 v171, v175
    v_add_f32_dpp v168, v172, v168 row_ror:8 row_mask:0xf bank_mask:0xf
    v_add_f32_dpp v169, v173, v169 row_ror:8 row_mask:0xf bank_mask:0xf
    v_add_f32_dpp v170, v174, v170 row_ror:8 row_mask:0xf bank_mask:0xf
    v_add_f32_dpp v171, v175, v171 row_ror:8 row_mask:0xf bank_mask:0xf
    s_mov_b32 exec_lo, 0xff00ff
    s_mov_b32 exec_hi, 0xff00ff
    ds_write_b32 v22, v168 offset:17408
    ds_write_b32 v22, v169 offset:17440
    ds_write_b32 v22, v170 offset:17472
    ds_write_b32 v22, v171 offset:17504
    s_mov_b64 exec, -1
    s_waitcnt lgkmcnt(0)
    s_barrier
    s_cmp_lg_u32 s5, 7
    s_cbranch_scc1 L_FIN
    ds_read_b128 v[136:139], v23 offset:17408
    ds_read_b128 v[140:143], v23 offset:17424
    ds_read_b128 v[144:147], v23 offset:19712
    ds_read_b128 v[148:151], v23 offset:19728
    s_waitcnt lgkmcnt(2)
    v_pk_add_f32 v[136:137], v[136:137], v[138:139]
    v_pk_add_f32 v[140:141], v[140:141], v[142:143]
    v_pk_add_f32 v[136:137], v[136:137], v[140:141]
    v_add_f32 v136, v136, v137
    v_mul_f32 v137, v136, v136
    v_mul_f32 v137, 0xbdd2d3e8, v137
    v_add_f32 v137, 0xc0135761, v137
    s_waitcnt lgkmcnt(0)
    v_mul_f32 v137, v137, v136
    v_exp_f32 v137, v137
    v_pk_add_f32 v[144:145], v[144:145], v[146:147]
    v_pk_add_f32 v[148:149], v[148:149], v[150:151]
    v_add_f32 v137, 1.0, v137
    v_rcp_f32 v137, v137
    v_pk_add_f32 v[144:145], v[144:145], v[148:149]
    v_add_f32 v180, v144, v145
    v_mul_f32 v178, v136, v137
    v_mul_f32 v178, v178, v180
    v_cvt_pk_bf16_f32 v178, v178, v178
    s_cmp_eq_u32 s98, 0
    s_cbranch_scc1 SL_71
    buffer_store_dwordx2 v[178:179], v20, s[44:47], s14 offen
SL_72:
    s_endpgm
RC_65:
    s_mov_b32 s7, 20000
    s_branch AW_75
AL_73:
    buffer_load_dwordx3 v[104:106], v24, s[44:47], s70 offen sc1
    buffer_load_dwordx3 v[108:110], v24, s[44:47], s71 offen sc1
    buffer_load_dwordx3 v[112:114], v25, s[44:47], s70 offen offset:256 sc1
    buffer_load_dwordx3 v[116:118], v24, s[44:47], s70 offen offset:2304 sc1
    buffer_load_dwordx3 v[120:122], v24, s[44:47], s71 offen offset:2304 sc1
    buffer_load_dwordx3 v[124:126], v25, s[44:47], s70 offen offset:2560 sc1
    buffer_load_dwordx3 v[128:130], v24, s[44:47], s72 offen sc1
    buffer_load_dwordx3 v[132:134], v24, s[44:47], s73 offen sc1
    buffer_load_dwordx3 v[136:138], v25, s[44:47], s72 offen offset:256 sc1
    s_waitcnt vmcnt(0)
    v_bitop3_b32 v30, v106, v110, s6 bitop3:0x7e
    v_bitop3_b32 v30, v30, v114, s6 bitop3:0xf6
    v_bitop3_b32 v30, v30, v118, s6 bitop3:0xf6
    v_bitop3_b32 v30, v30, v122, s6 bitop3:0xf6
    v_bitop3_b32 v30, v30, v126, s6 bitop3:0xf6
    v_bitop3_b32 v30, v30, v130, s6 bitop3:0xf6
    v_bitop3_b32 v30, v30, v134, s6 bitop3:0xf6
    v_bitop3_b32 v30, v30, v138, s6 bitop3:0xf6
    v_cmp_ne_u32 vcc, 0, v30
AW_75:
    s_cmp_eq_u64 exec, -1
    s_cselect_b64 s[94:95], -1, 0
    s_andn2_b64 s[94:95], s[94:95], vcc
    s_cmp_eq_u64 s[94:95], -1
    s_cbranch_scc1 AD_74
    s_ff1_i32_b64 s94, vcc
    s_lshl_b64 s[94:95], 1, s94
    s_cmp_eq_u64 vcc, 0
    s_cselect_b64 exec, -1, s[94:95]
    s_sub_u32 s7, s7, 1
    s_cbranch_scc0 AL_73
    s_mov_b64 exec, -1
    s_branch AD_74
PAD_20:
    s_branch L_WRET
AD_74:
    s_branch RC_66
PAD_21:
    s_branch L_WRET
PAD_22:
    s_branch L_WRET
L_YO:
    s_cmp_ge_u32 s4, 14
    s_cbranch_scc1 L_YG
    s_mov_b32 s48, s26
    s_mov_b32 s49, s27
    s_mov_b32 s50, 0x480000
    s_mov_b32 s51, 0x00020000
    v_mul_u32_u24 v28, 1152, v3
    v_lshl_add_u32 v28, v2, 4, v28
    v_add_u32 v29, 36864, v28
    s_lshl_b32 s8, s3, 3
    s_add_u32 s8, s8, s5
    s_mul_i32 s9, s8, 73728
    s_sub_u32 s12, s4, 9
    s_lshl_b32 s12, s12, 8
    s_min_u32 s12, s12, 896
    s_add_u32 s9, s9, s12
    buffer_load_dwordx4 v[32:35], v28, s[48:51], s9 offen nt
    buffer_load_dwordx4 v[36:39], v29, s[48:51], s9 offen nt
    s_add_u32 s9, s9, 4608
    buffer_load_dwordx4 v[40:43], v28, s[48:51], s9 offen nt
    v_lshlrev_b32 v23, 9, v3
    v_lshl_add_u32 v23, v2, 4, v23
    s_lshr_b32 s10, s8, 1
    s_lshl_b32 s10, s10, 11
    s_and_b32 s8, s5, 1
    s_lshl_b32 s8, s8, 8
    s_add_u32 s10, s10, s8
    s_add_u32 s10, s10, 409600
    s_mul_i32 s11, s3, 2304
    s_lshl_b32 s12, s12, 1
    s_add_u32 s11, s11, s12
    s_add_u32 s11, s11, 491520
    s_cmp_eq_u32 s4, 13
    s_cselect_b32 s12, 0, 0x55555555
    s_mov_b32 s13, 0x55555555
    s_mul_i32 s8, s5, 528
    v_and_b32 v30, 1, v3
    v_lshlrev_b32 v30, 4, v30
    v_lshl_add_u32 v26, v2, 5, v30
    v_lshrrev_b32 v30, 1, v3
    v_lshl_add_u32 v26, v30, 3, v26
    v_add_u32 v26, s8, v26
    v_lshrrev_b32 v25, 1, v1
    v_lshlrev_b32 v25, 4, v25
    v_and_b32 v24, 1, v1
    v_mul_u32_u24 v24, 528, v24
    v_add_u32 v24, v24, v25
    s_waitcnt vmcnt(2)
    buffer_load_dwordx4 v[44:47], v29, s[48:51], s9 offen nt
    s_add_u32 s9, s9, 4608
    s_waitcnt vmcnt(2)
    buffer_load_dwordx4 v[48:51], v28, s[48:51], s9 offen nt
    s_waitcnt vmcnt(2)
    buffer_load_dwordx4 v[52:55], v29, s[48:51], s9 offen nt
    s_add_u32 s9, s9, 4608
    s_waitcnt vmcnt(2)
    buffer_load_dwordx4 v[56:59], v28, s[48:51], s9 offen nt
    s_waitcnt vmcnt(2)
    buffer_load_dwordx4 v[60:63], v29, s[48:51], s9 offen nt
    s_add_u32 s9, s9, 4608
    s_waitcnt vmcnt(2)
    buffer_load_dwordx4 v[64:67], v28, s[48:51], s9 offen nt
    s_waitcnt vmcnt(2)
    buffer_load_dwordx4 v[68:71], v29, s[48:51], s9 offen nt
    s_add_u32 s9, s9, 4608
    s_waitcnt vmcnt(2)
    buffer_load_dwordx4 v[72:75], v28, s[48:51], s9 offen nt
    s_waitcnt vmcnt(2)
    buffer_load_dwordx4 v[76:79], v29, s[48:51], s9 offen nt
    s_add_u32 s9, s9, 4608
    s_waitcnt vmcnt(2)
    buffer_load_dwordx4 v[80:83], v28, s[48:51], s9 offen nt
    s_waitcnt vmcnt(2)
    buffer_load_dwordx4 v[84:87], v29, s[48:51], s9 offen nt
    s_add_u32 s9, s9, 4608
    s_waitcnt vmcnt(2)
    buffer_load_dwordx4 v[88:91], v28, s[48:51], s9 offen nt
    s_waitcnt vmcnt(2)
    buffer_load_dwordx4 v[92:95], v29, s[48:51], s9 offen nt
    s_mov_b32 s7, 20000
PL_76:
    buffer_load_dwordx3 v[104:106], v23, s[44:47], s10 offen sc1
    s_waitcnt vmcnt(0)
    v_cmp_ne_u32 vcc, s6, v106
    s_cbranch_vccz PD_77
    s_sub_u32 s7, s7, 1
    s_cbranch_scc0 PL_76
    s_branch PD_77
PAD_23:
    s_branch L_WRET
PD_77:
    v_mfma_f32_16x16x16_bf16 v[108:111], v[8:9], v[104:105], 0
    s_nop 7
    v_cvt_pk_bf16_f32 v108, v108, v108
    v_mov_b32 v109, v108
    v_mov_b32 v110, v108
    s_nop 0
    v_mov_b32_dpp v109, v108 row_shr:4 row_mask:0xf bank_mask:0xa
    v_mov_b32_dpp v110, v108 row_shl:4 row_mask:0xf bank_mask:0x5
    s_nop 0
    v_and_b32_dpp v10, v109, v4 quad_perm:[0,0,0,0] row_mask:0xf bank_mask:0xf
    v_and_b32_dpp v11, v109, v5 quad_perm:[0,0,0,0] row_mask:0xf bank_mask:0xf
    v_and_b32_dpp v12, v109, v6 quad_perm:[0,0,0,0] row_mask:0xf bank_mask:0xf
    v_and_b32_dpp v13, v109, v7 quad_perm:[0,0,0,0] row_mask:0xf bank_mask:0xf
    v_and_b32_dpp v14, v109, v4 quad_perm:[1,1,1,1] row_mask:0xf bank_mask:0xf
    v_and_b32_dpp v15, v109, v5 quad_perm:[1,1,1,1] row_mask:0xf bank_mask:0xf
    v_and_b32_dpp v16, v109, v6 quad_perm:[1,1,1,1] row_mask:0xf bank_mask:0xf
    v_and_b32_dpp v17, v109, v7 quad_perm:[1,1,1,1] row_mask:0xf bank_mask:0xf
    v_mfma_f32_16x16x32_bf16 v[112:115], v[10:13], v[32:35], 0
    v_mfma_f32_16x16x32_bf16 v[116:119], v[10:13], v[36:39], 0
    v_and_b32_dpp v10, v109, v4 quad_perm:[2,2,2,2] row_mask:0xf bank_mask:0xf
    v_and_b32_dpp v11, v109, v5 quad_perm:[2,2,2,2] row_mask:0xf bank_mask:0xf
    v_and_b32_dpp v12, v109, v6 quad_perm:[2,2,2,2] row_mask:0xf bank_mask:0xf
    v_and_b32_dpp v13, v109, v7 quad_perm:[2,2,2,2] row_mask:0xf bank_mask:0xf
    v_mfma_f32_16x16x32_bf16 v[112:115], v[14:17], v[40:43], v[112:115]
    v_mfma_f32_16x16x32_bf16 v[116:119], v[14:17], v[44:47], v[116:119]
    v_and_b32_dpp v14, v109, v4 quad_perm:[3,3,3,3] row_mask:0xf bank_mask:0xf
    v_and_b32_dpp v15, v109, v5 quad_perm:[3,3,3,3] row_mask:0xf bank_mask:0xf
    v_and_b32_dpp v16, v109, v6 quad_perm:[3,3,3,3] row_mask:0xf bank_mask:0xf
    v_and_b32_dpp v17, v109, v7 quad_perm:[3,3,3,3] row_mask:0xf bank_mask:0xf
    v_mfma_f32_16x16x32_bf16 v[112:115], v[10:13], v[48:51], v[112:115]
    v_mfma_f32_16x16x32_bf16 v[116:119], v[10:13], v[52:55], v[116:119]
    v_and_b32_dpp v10, v110, v4 quad_perm:[0,0,0,0] row_mask:0xf bank_mask:0xf
    v_and_b32_dpp v11, v110, v5 quad_perm:[0,0,0,0] row_mask:0xf bank_mask:0xf
    v_and_b32_dpp v12, v110, v6 quad_perm:[0,0,0,0] row_mask:0xf bank_mask:0xf
    v_and_b32_dpp v13, v110, v7 quad_perm:[0,0,0,0] row_mask:0xf bank_mask:0xf
    v_mfma_f32_16x16x32_bf16 v[112:115], v[14:17], v[56:59], v[112:115]
    v_mfma_f32_16x16x32_bf16 v[116:119], v[14:17], v[60:63], v[116:119]
    v_and_b32_dpp v14, v110, v4 quad_perm:[1,1,1,1] row_mask:0xf bank_mask:0xf
    v_and_b32_dpp v15, v110, v5 quad_perm:[1,1,1,1] row_mask:0xf bank_mask:0xf
    v_and_b32_dpp v16, v110, v6 quad_perm:[1,1,1,1] row_mask:0xf bank_mask:0xf
    v_and_b32_dpp v17, v110, v7 quad_perm:[1,1,1,1] row_mask:0xf bank_mask:0xf
    v_mfma_f32_16x16x32_bf16 v[112:115], v[10:13], v[64:67], v[112:115]
    v_mfma_f32_16x16x32_bf16 v[116:119], v[10:13], v[68:71], v[116:119]
    v_and_b32_dpp v10, v110, v4 quad_perm:[2,2,2,2] row_mask:0xf bank_mask:0xf
    v_and_b32_dpp v11, v110, v5 quad_perm:[2,2,2,2] row_mask:0xf bank_mask:0xf
    v_and_b32_dpp v12, v110, v6 quad_perm:[2,2,2,2] row_mask:0xf bank_mask:0xf
    v_and_b32_dpp v13, v110, v7 quad_perm:[2,2,2,2] row_mask:0xf bank_mask:0xf
    v_mfma_f32_16x16x32_bf16 v[112:115], v[14:17], v[72:75], v[112:115]
    v_mfma_f32_16x16x32_bf16 v[116:119], v[14:17], v[76:79], v[116:119]
    v_and_b32_dpp v14, v110, v4 quad_perm:[3,3,3,3] row_mask:0xf bank_mask:0xf
    v_and_b32_dpp v15, v110, v5 quad_perm:[3,3,3,3] row_mask:0xf bank_mask:0xf
    v_and_b32_dpp v16, v110, v6 quad_perm:[3,3,3,3] row_mask:0xf bank_mask:0xf
    v_and_b32_dpp v17, v110, v7 quad_perm:[3,3,3,3] row_mask:0xf bank_mask:0xf
    v_mfma_f32_16x16x32_bf16 v[112:115], v[10:13], v[80:83], v[112:115]
    v_mfma_f32_16x16x32_bf16 v[116:119], v[10:13], v[84:87], v[116:119]
    v_mfma_f32_16x16x32_bf16 v[112:115], v[14:17], v[88:91], v[112:115]
    v_mfma_f32_16x16x32_bf16 v[116:119], v[14:17], v[92:95], v[116:119]
    s_nop 7
    v_permlane32_swap_b32 v116, v114
    v_permlane32_swap_b32 v117, v115
    s_nop 0
    v_add_f32_dpp v120, v112, v114 quad_perm:[0,1,2,3] row_mask:0x3 bank_mask:0xf
    v_add_f32_dpp v121, v113, v115 quad_perm:[0,1,2,3] row_mask:0x3 bank_mask:0xf
    s_nop 0
    v_add_f32_dpp v120, v116, v118 quad_perm:[0,1,2,3] row_mask:0xc bank_mask:0xf
    v_add_f32_dpp v121, v117, v119 quad_perm:[0,1,2,3] row_mask:0xc bank_mask:0xf
    ds_write_b64 v26, v[120:121] offset:8192
    s_waitcnt lgkmcnt(0)
    s_barrier
    s_cmp_lg_u32 s5, 7
    s_cbranch_scc1 L_FIN
    ds_read_b128 v[136:139], v24 offset:8192
    ds_read_b128 v[140:143], v24 offset:9248
    ds_read_b128 v[144:147], v24 offset:10304
    ds_read_b128 v[148:151], v24 offset:11360
    s_waitcnt lgkmcnt(2)
    v_add_f32 v136, v136, v140
    v_add_f32 v137, v137, v141
    v_add_f32 v138, v138, v142
    v_add_f32 v139, v139, v143
    s_waitcnt lgkmcnt(1)
    v_add_f32 v136, v136, v144
    v_add_f32 v137, v137, v145
    v_add_f32 v138, v138, v146
    v_add_f32 v139, v139, v147
    s_waitcnt lgkmcnt(0)
    v_add_f32 v136, v136, v148
    v_add_f32 v137, v137, v149
    v_add_f32 v138, v138, v150
    v_add_f32 v139, v139, v151
    v_add_f32_dpp v136, v136, v136 quad_perm:[1,0,3,2] row_mask:0xf bank_mask:0xf
    v_add_f32_dpp v137, v137, v137 quad_perm:[1,0,3,2] row_mask:0xf bank_mask:0xf
    v_add_f32_dpp v138, v138, v138 quad_perm:[1,0,3,2] row_mask:0xf bank_mask:0xf
    v_add_f32_dpp v139, v139, v139 quad_perm:[1,0,3,2] row_mask:0xf bank_mask:0xf
    v_cvt_pk_bf16_f32 v130, v136, v137
    v_cvt_pk_bf16_f32 v131, v138, v139
    s_mov_b64 exec, s[12:13]
    buffer_store_dwordx4 v[130:133], v25, s[44:47], s11 offen sc1
    s_endpgm
PAD_24:
    s_branch L_WRET
L_YG:
    s_sub_u32 s8, s4, 14
    s_lshl_b32 s8, s8, 3
    s_add_u32 s66, s8, s3
    s_add_u32 s14, s66, 9
    s_mov_b32 s15, s5
    s_lshl_b32 s8, s5, 4
    s_add_u32 s66, s66, s8
    s_mov_b32 s48, s38
    s_mov_b32 s49, s39
    s_mov_b32 s50, 0x3cc000
    s_mov_b32 s51, 0x00020000
    s_mov_b32 s60, s36
    s_mov_b32 s61, s37
    s_mov_b32 s62, 0x480
    s_mov_b32 s63, 0x00020000
    v_lshl_add_u32 v21, v2, 2, v3
    v_lshlrev_b32 v21, 1, v21
    v_lshrrev_b32 v22, 3, v2
    v_lshl_add_u32 v22, v22, 2, v3
    v_lshlrev_b32 v22, 1, v22
    s_mul_i32 s8, s15, 144
    v_mul_u32_u24 v23, 6912, v3
    v_lshl_add_u32 v23, v2, 4, v23
    s_mul_i32 s9, s15, 497664
    s_lshl_b32 s10, s14, 8
    s_add_u32 s9, s9, s10
    v_add_u32 v20, 221184, v23
    s_add_u32 s10, s9, 221184
    s_movk_i32 s11, 27648
    buffer_load_ushort v24, v21, s[60:63], s8 offen
    buffer_load_ushort v25, v22, s[60:63], s8 offen offset:128
    buffer_load_dwordx4 v[32:35], v20, s[48:51], s10 offen nt
    s_add_u32 s10, s10, s11
    buffer_load_dwordx4 v[36:39], v20, s[48:51], s10 offen nt
    buffer_load_dwordx4 v[40:43], v23, s[48:51], s9 offen nt
    buffer_load_dwordx4 v[44:47], v20, s[48:51], s9 offen nt
    s_add_u32 s9, s9, s11
    buffer_load_dwordx4 v[48:51], v23, s[48:51], s9 offen nt
    buffer_load_dwordx4 v[52:55], v20, s[48:51], s9 offen nt
    s_add_u32 s9, s9, s11
    s_branch PSK_33
PAD_33:
    s_branch L_WRET
PSK_33:
    s_waitcnt vmcnt(5)
    buffer_load_dwordx4 v[56:59], v23, s[48:51], s9 offen nt
    s_waitcnt vmcnt(5)
    buffer_load_dwordx4 v[60:63], v20, s[48:51], s9 offen nt
    s_add_u32 s9, s9, s11
    s_waitcnt vmcnt(5)
    buffer_load_dwordx4 v[64:67], v23, s[48:51], s9 offen nt
    s_waitcnt vmcnt(5)
    buffer_load_dwordx4 v[68:71], v20, s[48:51], s9 offen nt
    s_add_u32 s9, s9, s11
    s_waitcnt vmcnt(5)
    buffer_load_dwordx4 v[72:75], v23, s[48:51], s9 offen nt
    s_waitcnt vmcnt(5)
    buffer_load_dwordx4 v[76:79], v20, s[48:51], s9 offen nt
    s_add_u32 s9, s9, s11
    s_waitcnt vmcnt(5)
    buffer_load_dwordx4 v[80:83], v23, s[48:51], s9 offen nt
    s_waitcnt vmcnt(5)
    buffer_load_dwordx4 v[84:87], v20, s[48:51], s9 offen nt
    s_add_u32 s9, s9, s11
    s_waitcnt vmcnt(5)
    buffer_load_dwordx4 v[88:91], v23, s[48:51], s9 offen nt
    s_waitcnt vmcnt(5)
    buffer_load_dwordx4 v[92:95], v20, s[48:51], s9 offen nt
    s_add_u32 s9, s9, s11
    s_waitcnt vmcnt(5)
    buffer_load_dwordx4 v[96:99], v23, s[48:51], s9 offen nt
    s_waitcnt vmcnt(5)
    buffer_load_dwordx4 v[100:103], v20, s[48:51], s9 offen nt
    s_mul_i32 s9, s15, 13824
    s_lshl_b32 s10, s14, 9
    s_add_u32 s9, s9, s10
    s_add_u32 s9, s9, 65536
    v_lshlrev_b32 v21, 5, v2
    v_lshl_add_u32 v21, v3, 4, v21
    v_mov_b32 v30, s6
    v_mov_b32 v31, s6
    s_waitcnt vmcnt(6)
    v_lshlrev_b32 v24, 16, v24
    v_mul_f32 v26, 0xbfb8aa3b, v24
    v_exp_f32 v26, v26
    s_nop 0
    v_add_f32 v26, 1.0, v26
    v_rcp_f32 v26, v26
    s_nop 0
    v_mul_f32 v24, v24, v26
    v_cvt_pk_bf16_f32 v24, v24, v24
    v_lshlrev_b32 v25, 16, v25
    v_mul_f32 v27, 0xbfb8aa3b, v25
    v_exp_f32 v27, v27
    s_nop 0
    v_add_f32 v27, 1.0, v27
    v_rcp_f32 v27, v27
    s_nop 0
    v_mul_f32 v25, v25, v27
    v_cvt_pk_bf16_f32 v25, v25, v25
    v_mov_b32 v26, v24
    v_mov_b32 v27, v24
    s_nop 0
    v_mov_b32_dpp v26, v24 row_shr:4 row_mask:0xf bank_mask:0xa
    v_mov_b32_dpp v27, v24 row_shl:4 row_mask:0xf bank_mask:0x5
    v_and_b32 v10, v25, v4
    v_and_b32 v11, v25, v5
    v_and_b32 v12, v25, v6
    v_and_b32 v13, v25, v7
    v_and_b32_dpp v14, v26, v4 quad_perm:[0,0,0,0] row_mask:0xf bank_mask:0xf
    v_and_b32_dpp v15, v26, v5 quad_perm:[0,0,0,0] row_mask:0xf bank_mask:0xf
    v_and_b32_dpp v16, v26, v6 quad_perm:[0,0,0,0] row_mask:0xf bank_mask:0xf
    v_and_b32_dpp v17, v26, v7 quad_perm:[0,0,0,0] row_mask:0xf bank_mask:0xf
    v_mfma_f32_16x16x32_bf16 v[104:107], v[10:13], v[32:35], 0
    v_mfma_f32_16x16x32_bf16 v[108:111], v[10:13], v[36:39], 0
    v_and_b32_dpp v10, v26, v4 quad_perm:[1,1,1,1] row_mask:0xf bank_mask:0xf
    v_and_b32_dpp v11, v26, v5 quad_perm:[1,1,1,1] row_mask:0xf bank_mask:0xf
    v_and_b32_dpp v12, v26, v6 quad_perm:[1,1,1,1] row_mask:0xf bank_mask:0xf
    v_and_b32_dpp v13, v26, v7 quad_perm:[1,1,1,1] row_mask:0xf bank_mask:0xf
    v_mfma_f32_16x16x32_bf16 v[104:107], v[14:17], v[40:43], v[104:107]
    v_mfma_f32_16x16x32_bf16 v[108:111], v[14:17], v[44:47], v[108:111]
    v_and_b32_dpp v14, v26, v4 quad_perm:[2,2,2,2] row_mask:0xf bank_mask:0xf
    v_and_b32_dpp v15, v26, v5 quad_perm:[2,2,2,2] row_mask:0xf bank_mask:0xf
    v_and_b32_dpp v16, v26, v6 quad_perm:[2,2,2,2] row_mask:0xf bank_mask:0xf
    v_and_b32_dpp v17, v26, v7 quad_perm:[2,2,2,2] row_mask:0xf bank_mask:0xf
    v_mfma_f32_16x16x32_bf16 v[104:107], v[10:13], v[48:51], v[104:107]
    v_mfma_f32_16x16x32_bf16 v[108:111], v[10:13], v[52:55], v[108:111]
    v_and_b32_dpp v10, v26, v4 quad_perm:[3,3,3,3] row_mask:0xf bank_mask:0xf
    v_and_b32_dpp v11, v26, v5 quad_perm:[3,3,3,3] row_mask:0xf bank_mask:0xf
    v_and_b32_dpp v12, v26, v6 quad_perm:[3,3,3,3] row_mask:0xf bank_mask:0xf
    v_and_b32_dpp v13, v26, v7 quad_perm:[3,3,3,3] row_mask:0xf bank_mask:0xf
    v_mfma_f32_16x16x32_bf16 v[104:107], v[14:17], v[56:59], v[104:107]
    v_mfma_f32_16x16x32_bf16 v[108:111], v[14:17], v[60:63], v[108:111]
    v_and_b32_dpp v14, v27, v4 quad_perm:[0,0,0,0] row_mask:0xf bank_mask:0xf
    v_and_b32_dpp v15, v27, v5 quad_perm:[0,0,0,0] row_mask:0xf bank_mask:0xf
    v_and_b32_dpp v16, v27, v6 quad_perm:[0,0,0,0] row_mask:0xf bank_mask:0xf
    v_and_b32_dpp v17, v27, v7 quad_perm:[0,0,0,0] row_mask:0xf bank_mask:0xf
    v_mfma_f32_16x16x32_bf16 v[104:107], v[10:13], v[64:67], v[104:107]
    v_mfma_f32_16x16x32_bf16 v[108:111], v[10:13], v[68:71], v[108:111]
    v_and_b32_dpp v10, v27, v4 quad_perm:[1,1,1,1] row_mask:0xf bank_mask:0xf
    v_and_b32_dpp v11, v27, v5 quad_perm:[1,1,1,1] row_mask:0xf bank_mask:0xf
    v_and_b32_dpp v12, v27, v6 quad_perm:[1,1,1,1] row_mask:0xf bank_mask:0xf
    v_and_b32_dpp v13, v27, v7 quad_perm:[1,1,1,1] row_mask:0xf bank_mask:0xf
    v_mfma_f32_16x16x32_bf16 v[104:107], v[14:17], v[72:75], v[104:107]
    v_mfma_f32_16x16x32_bf16 v[108:111], v[14:17], v[76:79], v[108:111]
    v_and_b32_dpp v14, v27, v4 quad_perm:[2,2,2,2] row_mask:0xf bank_mask:0xf
    v_and_b32_dpp v15, v27, v5 quad_perm:[2,2,2,2] row_mask:0xf bank_mask:0xf
    v_and_b32_dpp v16, v27, v6 quad_perm:[2,2,2,2] row_mask:0xf bank_mask:0xf
    v_and_b32_dpp v17, v27, v7 quad_perm:[2,2,2,2] row_mask:0xf bank_mask:0xf
    s_waitcnt vmcnt(4)
    v_mfma_f32_16x16x32_bf16 v[104:107], v[10:13], v[80:83], v[104:107]
    v_mfma_f32_16x16x32_bf16 v[108:111], v[10:13], v[84:87], v[108:111]
    v_and_b32_dpp v10, v27, v4 quad_perm:[3,3,3,3] row_mask:0xf bank_mask:0xf
    v_and_b32_dpp v11, v27, v5 quad_perm:[3,3,3,3] row_mask:0xf bank_mask:0xf
    v_and_b32_dpp v12, v27, v6 quad_perm:[3,3,3,3] row_mask:0xf bank_mask:0xf
    v_and_b32_dpp v13, v27, v7 quad_perm:[3,3,3,3] row_mask:0xf bank_mask:0xf
    s_waitcnt vmcnt(2)
    v_mfma_f32_16x16x32_bf16 v[104:107], v[14:17], v[88:91], v[104:107]
    v_mfma_f32_16x16x32_bf16 v[108:111], v[14:17], v[92:95], v[108:111]
    s_waitcnt vmcnt(0)
    v_mfma_f32_16x16x32_bf16 v[104:107], v[10:13], v[96:99], v[104:107]
    v_mfma_f32_16x16x32_bf16 v[108:111], v[10:13], v[100:103], v[108:111]
    s_nop 7
    v_permlane32_swap_b32 v108, v106
    v_permlane32_swap_b32 v109, v107
    s_nop 0
    v_add_f32_dpp v22, v104, v106 quad_perm:[0,1,2,3] row_mask:0x3 bank_mask:0xf
    v_add_f32_dpp v23, v105, v107 quad_perm:[0,1,2,3] row_mask:0x3 bank_mask:0xf
    s_nop 0
    v_add_f32_dpp v22, v108, v110 quad_perm:[0,1,2,3] row_mask:0xc bank_mask:0xf
    v_add_f32_dpp v23, v109, v111 quad_perm:[0,1,2,3] row_mask:0xc bank_mask:0xf
    v_cvt_pk_bf16_f32 v28, v22, v23
    v_mov_b32 v29, v28
    s_nop 1
    v_permlane32_swap_b32 v28, v29
    s_mov_b32 exec_lo, 0xffffffff
    s_mov_b32 exec_hi, 0x0
    buffer_store_dwordx4 v[28:31], v21, s[44:47], s9 offen sc1
    s_mov_b64 exec, -1
    s_cmp_ge_u32 s66, 18
    s_cbranch_scc1 L_FIN
    s_mov_b32 s48, s40
    s_mov_b32 s49, s41
    s_mov_b32 s50, 0x480
    s_mov_b32 s51, 0x00020000
    s_mov_b32 s60, s16
    s_mov_b32 s61, s17
    s_mov_b32 s62, 0x480
    s_mov_b32 s63, 0x00020000
    v_and_b32 v20, 7, v2
    v_lshl_add_u32 v21, v20, 2, v3
    v_lshlrev_b32 v21, 1, v21
    s_lshl_b32 s70, s66, 6
    v_lshlrev_b32 v20, 4, v20
    v_lshrrev_b32 v22, 3, v2
    v_lshl_add_u32 v22, v3, 1, v22
    v_mul_u32_u24 v23, 2304, v22
    v_add_u32 v23, v23, v20
    v_mul_u32_u24 v24, 13824, v22
    v_add_u32 v24, v24, v20
    v_lshl_add_u32 v22, v22, 8, v20
    s_lshl_b32 s8, s66, 7
    s_add_u32 s10, s8, 70144
    s_add_u32 s11, s10, 6912
    s_add_u32 s12, s8, 491520
    s_lshr_b32 s8, s66, 1
    s_lshl_b32 s71, s8, 14
    s_and_b32 s8, s66, 1
    s_lshl_b32 s8, s8, 7
    s_add_u32 s71, s71, s8
    s_add_u32 s71, s71, 524288
    s_add_u32 s72, s71, 4096
    s_add_u32 s73, s72, 4096
    s_add_u32 s74, s73, 4096
    buffer_load_ushort v30, v21, s[60:63], s70 offen
    buffer_load_ushort v31, v21, s[48:51], s70 offen
    buffer_load_dwordx3 v[136:138], v22, s[44:47], s71 offen sc1
    buffer_load_dwordx3 v[140:142], v22, s[44:47], s71 offen offset:2048 sc1
    buffer_load_dwordx3 v[144:146], v22, s[44:47], s72 offen sc1
    buffer_load_dwordx3 v[148:150], v22, s[44:47], s72 offen offset:2048 sc1
    buffer_load_dwordx3 v[152:154], v22, s[44:47], s73 offen sc1
    buffer_load_dwordx3 v[156:158], v22, s[44:47], s73 offen offset:2048 sc1
    buffer_load_dwordx3 v[160:162], v22, s[44:47], s74 offen sc1
    buffer_load_dwordx3 v[164:166], v22, s[44:47], s74 offen offset:2048 sc1
    s_mov_b32 s7, 20000
PL_78:
    buffer_load_dwordx3 v[72:74], v24, s[44:47], s10 offen sc1
    buffer_load_dwordx3 v[76:78], v24, s[44:47], s11 offen sc1
    s_waitcnt vmcnt(0)
    v_bitop3_b32 v48, v74, v78, s6 bitop3:0x7e
    v_cmp_ne_u32 vcc, 0, v48
    s_cbranch_vccz PD_79
    s_sub_u32 s7, s7, 1
    s_cbranch_scc0 PL_78
    s_branch PD_79
PAD_25:
    s_branch L_WRET
PD_79:
    v_mfma_f32_16x16x16_bf16 v[88:91], v[8:9], v[72:73], 0
    v_mfma_f32_16x16x16_bf16 v[92:95], v[8:9], v[76:77], 0
    v_lshlrev_b32 v30, 16, v30
    s_nop 5
    v_add_f32_dpp v88, v88, v88 row_ror:8 row_mask:0xf bank_mask:0xf
    v_add_f32_dpp v92, v92, v92 row_ror:8 row_mask:0xf bank_mask:0xf
    s_mov_b32 s7, 20000
PL_80:
    buffer_load_dwordx3 v[80:82], v23, s[44:47], s12 offen sc1
    s_waitcnt vmcnt(0)
    v_cmp_ne_u32 vcc, s6, v82
    s_cbranch_vccz PD_81
    s_sub_u32 s7, s7, 1
    s_cbranch_scc0 PL_80
    s_branch PD_81
PAD_26:
    s_branch L_WRET
PD_81:
    v_mfma_f32_16x16x16_bf16 v[84:87], v[8:9], v[80:81], 0
    s_nop 7
    v_add_f32_dpp v84, v84, v84 row_ror:8 row_mask:0xf bank_mask:0xf
    v_fmac_f32 v30, v88, v84
    s_cmp_lg_u32 s66, 0
    s_cbranch_scc1 L_YEP
    s_mov_b32 exec_lo, 0x1
    s_mov_b32 exec_hi, 0x0
    v_mov_b32 v50, 0
    v_mov_b32 v51, s6
    buffer_store_dword v51, v50, s[44:47], 0 offen sc1
    s_mov_b64 exec, -1
L_YEP:
    s_mov_b32 s7, 20000
PL_82:
    buffer_load_dwordx3 v[136:138], v22, s[44:47], s71 offen sc1
    buffer_load_dwordx3 v[140:142], v22, s[44:47], s71 offen offset:2048 sc1
    buffer_load_dwordx3 v[144:146], v22, s[44:47], s72 offen sc1
    buffer_load_dwordx3 v[148:150], v22, s[44:47], s72 offen offset:2048 sc1
    buffer_load_dwordx3 v[152:154], v22, s[44:47], s73 offen sc1
    buffer_load_dwordx3 v[156:158], v22, s[44:47], s73 offen offset:2048 sc1
    buffer_load_dwordx3 v[160:162], v22, s[44:47], s74 offen sc1
    buffer_load_dwordx3 v[164:166], v22, s[44:47], s74 offen offset:2048 sc1
    s_waitcnt vmcnt(0)
    v_bitop3_b32 v48, v138, v142, s6 bitop3:0x7e
    v_bitop3_b32 v48, v48, v146, s6 bitop3:0xf6
    v_bitop3_b32 v48, v48, v150, s6 bitop3:0xf6
    v_bitop3_b32 v48, v48, v154, s6 bitop3:0xf6
    v_bitop3_b32 v48, v48, v158, s6 bitop3:0xf6
    v_bitop3_b32 v48, v48, v162, s6 bitop3:0xf6
    v_bitop3_b32 v48, v48, v166, s6 bitop3:0xf6
    v_cmp_ne_u32 vcc, 0, v48
    s_cbranch_vccz PD_83
    s_sub_u32 s7, s7, 1
    s_cbranch_scc0 PL_82
    s_branch PD_83
PAD_27:
    s_branch L_WRET
PD_83:
    v_mfma_f32_16x16x16_bf16 v[84:87], v[8:9], v[136:137], 0
    v_mfma_f32_16x16x16_bf16 v[96:99], v[8:9], v[140:141], 0
    v_mfma_f32_16x16x16_bf16 v[84:87], v[8:9], v[144:145], v[84:87]
    v_mfma_f32_16x16x16_bf16 v[96:99], v[8:9], v[148:149], v[96:99]
    v_mfma_f32_16x16x16_bf16 v[84:87], v[8:9], v[152:153], v[84:87]
    v_mfma_f32_16x16x16_bf16 v[96:99], v[8:9], v[156:157], v[96:99]
    v_mfma_f32_16x16x16_bf16 v[84:87], v[8:9], v[160:161], v[84:87]
    v_mfma_f32_16x16x16_bf16 v[96:99], v[8:9], v[164:165], v[96:99]
    s_nop 7
    v_add_f32 v84, v84, v96
    s_nop 1
    v_add_f32_dpp v84, v84, v84 row_ror:8 row_mask:0xf bank_mask:0xf
    v_fmac_f32 v30, v92, v84
    v_cvt_pk_bf16_f32 v30, v30, v30
    s_mov_b32 exec_lo, 0xff00ff
    s_mov_b32 exec_hi, 0xff00ff
    buffer_store_short v30, v21, s[48:51], s70 offen nt
L_FIN:
    s_endpgm
PAD_28:
    s_branch L_WRET
L_COLD:
L_XPSLOW:
    s_mov_b32 s92, 0x7f800000
    s_waitcnt lgkmcnt(0)
    s_branch L_XP1
L_XH2C:
    s_nop 11
    v_mfma_f32_32x32x16_bf16 v[176:191], v[192:195], v[64:67], 0
    v_mfma_f32_32x32x16_bf16 v[176:191], v[196:199], v[68:71], v[176:191]
    v_cvt_pk_bf16_f32 v32, v160, v161
    v_cvt_pk_bf16_f32 v33, v162, v163
    v_cvt_pk_bf16_f32 v34, v164, v165
    v_cvt_pk_bf16_f32 v35, v166, v167
    buffer_store_dwordx4 v[32:35], v20, s[44:47], s70 offen sc1
    s_xor_b32 s70, s70, 8192
    v_mfma_f32_32x32x16_bf16 v[176:191], v[200:203], v[72:75], v[176:191]
    v_cvt_pk_bf16_f32 v36, v168, v169
    v_cvt_pk_bf16_f32 v37, v170, v171
    v_cvt_pk_bf16_f32 v38, v172, v173
    v_cvt_pk_bf16_f32 v39, v174, v175
    buffer_store_dwordx4 v[36:39], v20, s[44:47], s71 offen sc1
    s_xor_b32 s71, s71, 8192
    v_mfma_f32_32x32x16_bf16 v[176:191], v[204:207], v[76:79], v[176:191]
    v_mfma_f32_32x32x16_bf16 v[176:191], v[208:211], v[80:83], v[176:191]
    v_mfma_f32_32x32x16_bf16 v[176:191], v[212:215], v[84:87], v[176:191]
    s_barrier
    v_mfma_f32_32x32x16_bf16 v[176:191], v[216:219], v[88:91], v[176:191]
    v_mfma_f32_32x32x16_bf16 v[176:191], v[220:223], v[92:95], v[176:191]
    v_mfma_f32_32x32x16_bf16 v[160:175], v[192:195], v[96:99], 0
    v_mfma_f32_32x32x16_bf16 v[160:175], v[196:199], v[100:103], v[160:175]
    s_nop 9
    v_cvt_pk_bf16_f32 v64, v176, v177
    v_cvt_pk_bf16_f32 v65, v178, v179
    v_cvt_pk_bf16_f32 v66, v180, v181
    v_cvt_pk_bf16_f32 v67, v182, v183
    buffer_store_dwordx4 v[64:67], v20, s[44:47], s70 offen sc1
    s_xor_b32 s70, s70, 24576
    v_mfma_f32_32x32x16_bf16 v[160:175], v[200:203], v[104:107], v[160:175]
    v_cvt_pk_bf16_f32 v68, v184, v185
    v_cvt_pk_bf16_f32 v69, v186, v187
    v_cvt_pk_bf16_f32 v70, v188, v189
    v_cvt_pk_bf16_f32 v71, v190, v191
    buffer_store_dwordx4 v[68:71], v20, s[44:47], s71 offen sc1
    s_xor_b32 s71, s71, 24576
    v_mfma_f32_32x32x16_bf16 v[160:175], v[204:207], v[108:111], v[160:175]
    v_mfma_f32_32x32x16_bf16 v[160:175], v[208:211], v[112:115], v[160:175]
    v_mfma_f32_32x32x16_bf16 v[160:175], v[212:215], v[116:119], v[160:175]
    v_mfma_f32_32x32x16_bf16 v[160:175], v[216:219], v[120:123], v[160:175]
    v_mfma_f32_32x32x16_bf16 v[160:175], v[220:223], v[124:127], v[160:175]
    v_mfma_f32_32x32x16_bf16 v[176:191], v[192:195], v[128:131], 0
    v_mfma_f32_32x32x16_bf16 v[176:191], v[196:199], v[132:135], v[176:191]
    s_nop 9
    v_cvt_pk_bf16_f32 v96, v160, v161
    v_cvt_pk_bf16_f32 v97, v162, v163
    v_cvt_pk_bf16_f32 v98, v164, v165
    v_cvt_pk_bf16_f32 v99, v166, v167
    buffer_store_dwordx4 v[96:99], v20, s[44:47], s70 offen sc1
    s_xor_b32 s70, s70, 8192
    v_mfma_f32_32x32x16_bf16 v[176:191], v[200:203], v[136:139], v[176:191]
    v_cvt_pk_bf16_f32 v100, v168, v169
    v_cvt_pk_bf16_f32 v101, v170, v171
    v_cvt_pk_bf16_f32 v102, v172, v173
    v_cvt_pk_bf16_f32 v103, v174, v175
    buffer_store_dwordx4 v[100:103], v20, s[44:47], s71 offen sc1
    s_xor_b32 s71, s71, 8192
    v_mfma_f32_32x32x16_bf16 v[176:191], v[204:207], v[140:143], v[176:191]
    v_mfma_f32_32x32x16_bf16 v[176:191], v[208:211], v[144:147], v[176:191]
    v_mfma_f32_32x32x16_bf16 v[176:191], v[212:215], v[148:151], v[176:191]
    v_mfma_f32_32x32x16_bf16 v[176:191], v[216:219], v[152:155], v[176:191]
    s_mov_b32 exec_lo, 0x1
    s_mov_b32 exec_hi, 0x0
    s_waitcnt vmcnt(2)
    buffer_store_dword v21, v22, s[44:47], s72 offen sc1
    s_mov_b64 exec, -1
    v_mfma_f32_32x32x16_bf16 v[176:191], v[220:223], v[156:159], v[176:191]
    s_nop 11
    v_cvt_pk_bf16_f32 v128, v176, v177
    v_cvt_pk_bf16_f32 v129, v178, v179
    v_cvt_pk_bf16_f32 v130, v180, v181
    v_cvt_pk_bf16_f32 v131, v182, v183
    buffer_store_dwordx4 v[128:131], v20, s[44:47], s70 offen sc1
    s_xor_b32 s70, s70, 8192
    v_cvt_pk_bf16_f32 v132, v184, v185
    v_cvt_pk_bf16_f32 v133, v186, v187
    v_cvt_pk_bf16_f32 v134, v188, v189
    v_cvt_pk_bf16_f32 v135, v190, v191
    buffer_store_dwordx4 v[132:135], v20, s[44:47], s71 offen sc1
    s_xor_b32 s71, s71, 8192
    s_mov_b32 exec_lo, 0x1
    s_mov_b32 exec_hi, 0x0
    s_waitcnt vmcnt(0)
    buffer_store_dword v21, v22, s[44:47], s74 offen sc1
    s_mov_b64 exec, -1
    s_branch L_XH2R
SL_15:
    s_mov_b32 exec_lo, 0x1
    s_mov_b32 exec_hi, 0x0
    buffer_store_dword v251, v20, s[44:47], s8 offen offset:1024 sc1
    s_branch SL_16
L_XSSLOW:
    v_max3_f32 v24, v88, v89, v90
    v_max_f32 v24, v24, v91
    v_mov_b32 v31, v24
    s_nop 1
    v_permlane32_swap_b32 v24, v31
    v_max_f32 v24, v24, v31
    v_ceil_f32 v24, v24
    s_mov_b32 s92, 0x7f800000
    v_sub_f32 v192, v192, v24
    v_sub_f32 v193, v193, v24
    v_sub_f32 v194, v194, v24
    v_sub_f32 v195, v195, v24
    v_sub_f32 v196, v196, v24
    v_sub_f32 v197, v197, v24
    v_sub_f32 v198, v198, v24
    v_sub_f32 v199, v199, v24
    v_sub_f32 v200, v200, v24
    v_sub_f32 v201, v201, v24
    v_sub_f32 v202, v202, v24
    v_sub_f32 v203, v203, v24
    v_sub_f32 v204, v204, v24
    v_sub_f32 v205, v205, v24
    v_sub_f32 v206, v206, v24
    v_sub_f32 v207, v207, v24
    s_nop 0
    s_branch L_XSM
SL_29:
    s_mov_b32 exec_lo, 0xffffffff
    s_mov_b32 exec_hi, 0x0
    buffer_store_dwordx4 v[72:75], v31, s[44:47], s8 offen sc1
    s_nop 0
    s_branch SL_30
SL_40:
    s_mov_b32 exec_lo, 0x55555555
    s_mov_b32 exec_hi, 0x55555555
    buffer_store_dwordx4 v[104:107], v25, s[44:47], s12 offen sc1
    s_nop 0
    s_branch SL_41
SL_51:
    s_mov_b32 exec_lo, 0x55555555
    s_mov_b32 exec_hi, 0x0
    buffer_store_dwordx4 v[128:131], v25, s[44:47], s14 offen sc1
    s_mov_b32 exec_lo, 0x0
    s_mov_b32 exec_hi, 0x55555555
    buffer_store_dwordx4 v[130:133], v25, s[44:47], s14 offen sc1
    s_nop 0
    s_branch SL_52
SL_55:
    s_mov_b32 exec_lo, 0x1
    s_mov_b32 exec_hi, 0x0
    buffer_store_dword v132, v27, s[44:47], s15 offen sc1
    s_branch SL_56
SL_71:
    buffer_store_dwordx2 v[178:179], v20, s[44:47], s14 offen sc1
    s_branch SL_72
L_END:
s_endpgm
.section .rodata,"a"
.p2align 6
.amdhsa_kernel adaLN_cond__compressed_kv_cla__geglu_ffn__decode_kernel
  .amdhsa_next_free_vgpr 256
  .amdhsa_next_free_sgpr 102
  .amdhsa_accum_offset 256
  .amdhsa_group_segment_fixed_size 0
  .amdhsa_kernarg_size 120
  .amdhsa_user_sgpr_count 2
  .amdhsa_user_sgpr_kernarg_segment_ptr 1
  .amdhsa_system_sgpr_workgroup_id_x 1
.end_amdhsa_kernel
```
